```python
import torch

def _softmax(x, axis=-1):
    return torch.softmax(x, dim=axis)
def _gelu(x):
    return torch.nn.functional.gelu(x, approximate="tanh")
def _silu(x):
    return torch.nn.functional.silu(x)
def _sigmoid(x):
    return torch.sigmoid(x)
def _layernorm(x, axis=-1, eps=1e-5):
    m = x.mean(dim=axis, keepdim=True)
    v = x.var(dim=axis, keepdim=True, unbiased=False)
    return (x - m) / torch.sqrt(v + eps)
def _scatter_add(tgt, idx, src, axis=0):
    return tgt.clone().index_add_(axis, idx, src)
def _segment_sum(src, seg, n):
    out = torch.zeros((n,) + src.shape[1:], dtype=src.dtype)
    return out.index_add_(0, seg, src)
def _pad(x, pw):
    flat = tuple(v for pair in reversed(pw) for v in pair)
    return torch.nn.functional.pad(x, flat)

kernel_name = 'gated_mix__compressed_kv_cla__glu_gated_reglu__decode'

def setup_inputs():

    _w = (lambda a: (lambda t: t.to(torch.bfloat16) if t.is_floating_point() else t)(torch.as_tensor(a)))
    def _A_setup():
        B, H, Sq, Sk, D, M = 4, 32, 1, 4096, 128, 512
        Dc = 4 * D
        return {
            "x": _w((lambda *s: torch.randn(*s, dtype=torch.bfloat16) * 0.05)(B, Sq, M)),
            "c_kv": _w((lambda *s: torch.randn(*s, dtype=torch.bfloat16) * 0.4)(B, Sk, Dc)),
            "w_q": _w((lambda *s: torch.randn(*s, dtype=torch.bfloat16) * 6.4)(M, H, D) * (M ** -0.5)),
            "w_uk": _w((lambda *s: torch.randn(*s, dtype=torch.bfloat16) * 6.4)(Dc, H, D) * (Dc ** -0.5)),
            "w_uv": _w((lambda *s: torch.randn(*s, dtype=torch.bfloat16) * 0.4)(Dc, H, D) * (Dc ** -0.5)),
            "w_o": _w((lambda *s: torch.randn(*s, dtype=torch.bfloat16) * 0.4)(H, D, M) * ((H * D) ** -0.5)),
        }
    _A_in = _A_setup()

    def _B_setup():
        B, S, D, F = 4, 1, 512, 1792
        return {
            "x": _w((lambda *s: torch.randn(*s, dtype=torch.bfloat16) * 0.05)(B, S, D)),
            "W_gate": _w((lambda *s: torch.randn(*s, dtype=torch.bfloat16) * 0.8)(D, F) * (2.0 / D) ** 0.5),
            "W_up": _w((lambda *s: torch.randn(*s, dtype=torch.bfloat16) * 0.8)(D, F) * (2.0 / D) ** 0.5),
            "W_down": _w((lambda *s: torch.randn(*s, dtype=torch.bfloat16) * 0.8)(F, D) * (1.0 / F) ** 0.5),
        }
    _B_in = _B_setup()

    return {
        "A_x": _A_in["x"],
        "A_c_kv": _A_in["c_kv"],
        "A_w_q": _A_in["w_q"],
        "A_w_uk": _A_in["w_uk"],
        "A_w_uv": _A_in["w_uv"],
        "A_w_o": _A_in["w_o"],
        "B_x": _B_in["x"],
        "B_W_gate": _B_in["W_gate"],
        "B_W_up": _B_in["W_up"],
        "B_W_down": _B_in["W_down"],
        "gate_w": _w((lambda *s: torch.randn(*s, dtype=torch.bfloat16) * 0.05)(512) * 16.0),
    }

def reference(A_x, A_c_kv, A_w_q, A_w_uk, A_w_uv, A_w_o, B_x, B_W_gate, B_W_up, B_W_down, gate_w):
    def _A_ref(x, c_kv, w_q, w_uk, w_uv, w_o):
        B, Sq, M = x.shape[0], x.shape[1], x.shape[2]
        Sk = c_kv.shape[1]
        H, D = w_q.shape[1], w_q.shape[2]
        q = torch.einsum("bqm,mhd->bhqd", x, w_q)
        k = torch.einsum("bkc,chd->bhkd", c_kv, w_uk)
        v = torch.einsum("bkc,chd->bhkd", c_kv, w_uv)
        scores = torch.einsum("bhqd,bhkd->bhqk", q, k) * (D ** -0.5)
        off = Sk - Sq
        qi = torch.arange(Sq)[:, None]
        kj = torch.arange(Sk)[None, :]
        cmask = kj <= (qi + off)
        scores = torch.where(cmask[None, None], scores, -1e9)
        p = _softmax(scores, axis=-1)
        ctx = torch.einsum("bhqk,bhkd->bhqd", p, v)
        return torch.einsum("bhqd,hdm->bqm", ctx, w_o)

    def _B_ref(x, W_gate, W_up, W_down):
        gate = torch.einsum("bsd,df->bsf", x, W_gate)
        up = torch.einsum("bsd,df->bsf", x, W_up)
        gate = gate * (lambda x, dt: x.to(dt))(gate > 0, gate.dtype)
        h = gate * up
        return torch.einsum("bsf,fd->bsd", h, W_down)

    x = A_x
    g = _sigmoid((x * gate_w).sum(-1, keepdims=True))
    a = _A_ref(x, A_c_kv, A_w_q, A_w_uk, A_w_uv, A_w_o)
    b = _B_ref(x, B_W_gate, B_W_up, B_W_down)
    return g * a + (1 - g) * b
```

```asm
; @launch kernel=k1_kernel grid=(256,1,1) block=(256,1,1) lds=32768
; @launch kernel=k1b_kernel grid=(256,1,1) block=(256,1,1) lds=0
; @launch kernel=k2_kernel grid=(256,1,1) block=(256,1,1) lds=107520
; @launch kernel=k3_kernel grid=(256,1,1) block=(256,1,1) lds=18432
; @launch kernel=k3b_kernel grid=(184,1,1) block=(256,1,1) lds=33024
; @launch kernel=k4_kernel grid=(64,1,1) block=(256,1,1) lds=2048
.amdgcn_target "amdgcn-amd-amdhsa--gfx950"
.text
.globl k1_kernel
.p2align 8
.type k1_kernel,@function
k1_kernel:
    s_cmp_ge_u32 s2, 256
    s_cbranch_scc1 K1_END
    s_load_dwordx4 s[4:7], s[0:1], 0
    s_load_dwordx2 s[8:9], s[0:1], 16
    s_load_dwordx4 s[12:15], s[0:1], 56
    s_load_dwordx2 s[16:17], s[0:1], 104
    v_and_b32 v1, 63, v0
    v_lshrrev_b32 v2, 6, v0
    s_nop 0
    v_readfirstlane_b32 s3, v2
    v_lshrrev_b32 v3, 4, v1
    v_and_b32 v4, 15, v1
    s_waitcnt lgkmcnt(0)
    s_mov_b32 s20, s4
    s_and_b32 s21, s5, 0xffff
    s_mov_b32 s22, 4096
    s_mov_b32 s23, 0x00020000
    s_mov_b32 s32, s16
    s_and_b32 s33, s17, 0xffff
    s_mov_b32 s34, 13631488
    s_mov_b32 s35, 0x00020000
    s_mov_b32 s64, s6
    s_and_b32 s65, s7, 0xffff
    s_mov_b32 s66, 16777216
    s_mov_b32 s67, 0x00020000
    v_lshlrev_b32 v62, 4, v0
    s_lshl_b32 s70, s2, 16
    s_cmp_lt_u32 s2, 240
    s_cbranch_scc1 K1_WORK
    s_branch K1_END
K1_WORK:
    s_cmp_ge_u32 s2, 128
    s_cbranch_scc1 K1_MLP
    s_mov_b32 s24, s8
    s_and_b32 s25, s9, 0xffff
    s_mov_b32 s26, 4194304
    s_mov_b32 s27, 0x00020000
    s_movk_i32 s40, 8192
    s_and_b32 s42, s2, 31
    s_lshr_b32 s43, s2, 5
    s_lshl_b32 s41, s42, 8
    s_lshl_b32 s44, s43, 6
    s_add_u32 s41, s41, s44
    s_branch K1_GO
K1_MLP:
    s_sub_u32 s44, s2, 128
    s_cmp_ge_u32 s44, 56
    s_cselect_b32 s45, 1, 0
    s_cselect_b32 s46, 56, 0
    s_cselect_b32 s8, s14, s12
    s_cselect_b32 s9, s15, s13
    s_sub_u32 s44, s44, s46
    s_mov_b32 s24, s8
    s_and_b32 s25, s9, 0xffff
    s_mov_b32 s26, 1835008
    s_mov_b32 s27, 0x00020000
    s_movk_i32 s40, 3584
    s_lshl_b32 s41, s44, 6
K1_GO:
    v_lshrrev_b32 v5, 2, v1
    v_and_b32 v6, 3, v1
    v_lshrrev_b32 v7, 3, v5
    v_lshlrev_b32 v7, 1, v7
    v_xor_b32 v6, v6, v7
    v_mul_lo_u32 v8, v5, s40
    v_lshl_add_u32 v8, v6, 4, v8
    v_add_u32 v8, s41, v8
    s_lshl_b32 s48, s40, 4
    s_lshl_b32 s49, s3, 3
    s_mul_i32 s49, s49, s48
    s_lshl_b32 s50, s3, 13
    s_add_u32 m0, s50, 0
    s_nop 0
    buffer_load_dwordx4 v8, s[24:27], s49 offen lds
    s_add_u32 s49, s49, s48
    s_add_u32 m0, s50, 1024
    s_nop 0
    buffer_load_dwordx4 v8, s[24:27], s49 offen lds
    s_add_u32 s49, s49, s48
    s_add_u32 m0, s50, 2048
    s_nop 0
    buffer_load_dwordx4 v8, s[24:27], s49 offen lds
    s_add_u32 s49, s49, s48
    s_add_u32 m0, s50, 3072
    s_nop 0
    buffer_load_dwordx4 v8, s[24:27], s49 offen lds
    s_add_u32 s49, s49, s48
    s_add_u32 m0, s50, 4096
    s_nop 0
    buffer_load_dwordx4 v8, s[24:27], s49 offen lds
    s_add_u32 s49, s49, s48
    s_add_u32 m0, s50, 5120
    s_nop 0
    buffer_load_dwordx4 v8, s[24:27], s49 offen lds
    s_add_u32 s49, s49, s48
    s_add_u32 m0, s50, 6144
    s_nop 0
    buffer_load_dwordx4 v8, s[24:27], s49 offen lds
    s_add_u32 s49, s49, s48
    s_add_u32 m0, s50, 7168
    s_nop 0
    buffer_load_dwordx4 v8, s[24:27], s49 offen lds
    s_add_u32 s49, s49, s48
    v_and_b32 v10, 3, v1
    v_lshlrev_b32 v10, 10, v10
    v_lshl_add_u32 v10, v3, 4, v10
    buffer_load_dwordx4 v[64:67], v10, s[20:23], 0 offen offset:0
    buffer_load_dwordx4 v[68:71], v10, s[20:23], 0 offen offset:64
    buffer_load_dwordx4 v[72:75], v10, s[20:23], 0 offen offset:128
    buffer_load_dwordx4 v[76:79], v10, s[20:23], 0 offen offset:192
    buffer_load_dwordx4 v[80:83], v10, s[20:23], 0 offen offset:256
    buffer_load_dwordx4 v[84:87], v10, s[20:23], 0 offen offset:320
    buffer_load_dwordx4 v[88:91], v10, s[20:23], 0 offen offset:384
    buffer_load_dwordx4 v[92:95], v10, s[20:23], 0 offen offset:448
    buffer_load_dwordx4 v[96:99], v10, s[20:23], 0 offen offset:512
    buffer_load_dwordx4 v[100:103], v10, s[20:23], 0 offen offset:576
    buffer_load_dwordx4 v[104:107], v10, s[20:23], 0 offen offset:640
    buffer_load_dwordx4 v[108:111], v10, s[20:23], 0 offen offset:704
    buffer_load_dwordx4 v[112:115], v10, s[20:23], 0 offen offset:768
    buffer_load_dwordx4 v[116:119], v10, s[20:23], 0 offen offset:832
    buffer_load_dwordx4 v[120:123], v10, s[20:23], 0 offen offset:896
    buffer_load_dwordx4 v[124:127], v10, s[20:23], 0 offen offset:960
    v_lshrrev_b32 v12, 2, v4
    v_and_b32 v13, 3, v4
    v_lshl_add_u32 v14, v3, 3, v12
    v_lshlrev_b32 v15, 6, v14
    v_lshrrev_b32 v16, 1, v13
    s_and_b32 s51, s3, 1
    v_mov_b32 v17, s51
    v_lshl_add_u32 v16, v17, 1, v16
    v_and_b32 v18, 1, v3
    v_lshlrev_b32 v18, 1, v18
    v_xor_b32 v16, v16, v18
    v_lshl_add_u32 v15, v16, 4, v15
    v_and_b32 v13, 1, v13
    v_lshl_add_u32 v15, v13, 3, v15
    v_mov_b32 v20, 0
    v_mov_b32 v21, 0
    v_mov_b32 v22, 0
    v_mov_b32 v23, 0
    s_waitcnt vmcnt(0)
    s_barrier
    s_cmp_ge_u32 s3, 2
    s_cbranch_scc1 K1_END
    ds_read_b64_tr_b16 v[24:25], v15 offset:0
    ds_read_b64_tr_b16 v[26:27], v15 offset:256
    ds_read_b64_tr_b16 v[28:29], v15 offset:2048
    ds_read_b64_tr_b16 v[30:31], v15 offset:2304
    ds_read_b64_tr_b16 v[32:33], v15 offset:4096
    ds_read_b64_tr_b16 v[34:35], v15 offset:4352
    ds_read_b64_tr_b16 v[36:37], v15 offset:6144
    ds_read_b64_tr_b16 v[38:39], v15 offset:6400
    s_waitcnt lgkmcnt(6)
    v_mfma_f32_16x16x32_bf16 v[20:23], v[64:67], v[24:27], v[20:23]
    ds_read_b64_tr_b16 v[24:25], v15 offset:8192
    ds_read_b64_tr_b16 v[26:27], v15 offset:8448
    s_waitcnt lgkmcnt(6)
    v_mfma_f32_16x16x32_bf16 v[20:23], v[68:71], v[28:31], v[20:23]
    ds_read_b64_tr_b16 v[28:29], v15 offset:10240
    ds_read_b64_tr_b16 v[30:31], v15 offset:10496
    s_waitcnt lgkmcnt(6)
    v_mfma_f32_16x16x32_bf16 v[20:23], v[72:75], v[32:35], v[20:23]
    ds_read_b64_tr_b16 v[32:33], v15 offset:12288
    ds_read_b64_tr_b16 v[34:35], v15 offset:12544
    s_waitcnt lgkmcnt(6)
    v_mfma_f32_16x16x32_bf16 v[20:23], v[76:79], v[36:39], v[20:23]
    ds_read_b64_tr_b16 v[36:37], v15 offset:14336
    ds_read_b64_tr_b16 v[38:39], v15 offset:14592
    s_waitcnt lgkmcnt(6)
    v_mfma_f32_16x16x32_bf16 v[20:23], v[80:83], v[24:27], v[20:23]
    ds_read_b64_tr_b16 v[24:25], v15 offset:16384
    ds_read_b64_tr_b16 v[26:27], v15 offset:16640
    s_waitcnt lgkmcnt(6)
    v_mfma_f32_16x16x32_bf16 v[20:23], v[84:87], v[28:31], v[20:23]
    ds_read_b64_tr_b16 v[28:29], v15 offset:18432
    ds_read_b64_tr_b16 v[30:31], v15 offset:18688
    s_waitcnt lgkmcnt(6)
    v_mfma_f32_16x16x32_bf16 v[20:23], v[88:91], v[32:35], v[20:23]
    ds_read_b64_tr_b16 v[32:33], v15 offset:20480
    ds_read_b64_tr_b16 v[34:35], v15 offset:20736
    s_waitcnt lgkmcnt(6)
    v_mfma_f32_16x16x32_bf16 v[20:23], v[92:95], v[36:39], v[20:23]
    ds_read_b64_tr_b16 v[36:37], v15 offset:22528
    ds_read_b64_tr_b16 v[38:39], v15 offset:22784
    s_waitcnt lgkmcnt(6)
    v_mfma_f32_16x16x32_bf16 v[20:23], v[96:99], v[24:27], v[20:23]
    ds_read_b64_tr_b16 v[24:25], v15 offset:24576
    ds_read_b64_tr_b16 v[26:27], v15 offset:24832
    s_waitcnt lgkmcnt(6)
    v_mfma_f32_16x16x32_bf16 v[20:23], v[100:103], v[28:31], v[20:23]
    ds_read_b64_tr_b16 v[28:29], v15 offset:26624
    ds_read_b64_tr_b16 v[30:31], v15 offset:26880
    s_waitcnt lgkmcnt(6)
    v_mfma_f32_16x16x32_bf16 v[20:23], v[104:107], v[32:35], v[20:23]
    ds_read_b64_tr_b16 v[32:33], v15 offset:28672
    ds_read_b64_tr_b16 v[34:35], v15 offset:28928
    s_waitcnt lgkmcnt(6)
    v_mfma_f32_16x16x32_bf16 v[20:23], v[108:111], v[36:39], v[20:23]
    ds_read_b64_tr_b16 v[36:37], v15 offset:30720
    ds_read_b64_tr_b16 v[38:39], v15 offset:30976
    s_waitcnt lgkmcnt(6)
    v_mfma_f32_16x16x32_bf16 v[20:23], v[112:115], v[24:27], v[20:23]
    s_waitcnt lgkmcnt(4)
    v_mfma_f32_16x16x32_bf16 v[20:23], v[116:119], v[28:31], v[20:23]
    s_waitcnt lgkmcnt(2)
    v_mfma_f32_16x16x32_bf16 v[20:23], v[120:123], v[32:35], v[20:23]
    s_waitcnt lgkmcnt(0)
    v_mfma_f32_16x16x32_bf16 v[20:23], v[124:127], v[36:39], v[20:23]
    s_nop 7
    s_nop 3
    v_cmp_gt_u32 vcc, 16, v1
    s_and_saveexec_b64 s[60:61], vcc
    s_cmp_ge_u32 s2, 128
    s_cbranch_scc0 K1_Q
    s_mul_i32 s52, s45, 28672
    s_lshl_b32 s53, s41, 1
    s_add_u32 s52, s52, s53
    s_lshl_b32 s53, s3, 6
    s_add_u32 s52, s52, s53
    s_add_u32 s52, s52, 524288
    v_lshlrev_b32 v5, 2, v1
    buffer_store_dword v20, v5, s[32:35], s52 offen
    s_add_u32 s52, s52, 7168
    buffer_store_dword v21, v5, s[32:35], s52 offen
    s_add_u32 s52, s52, 7168
    buffer_store_dword v22, v5, s[32:35], s52 offen
    s_add_u32 s52, s52, 7168
    buffer_store_dword v23, v5, s[32:35], s52 offen
    s_add_u32 s52, s52, 7168
    s_branch K1_END
K1_Q:
    s_lshl_b32 s53, s3, 5
    s_add_u32 s52, s41, s53
    s_add_u32 s52, s52, 262144
    v_lshlrev_b32 v5, 1, v1
    v_cvt_pk_bf16_f32 v20, v20, v20
    buffer_store_short v20, v5, s[32:35], s52 offen
    s_add_u32 s52, s52, 8192
    v_cvt_pk_bf16_f32 v21, v21, v21
    buffer_store_short v21, v5, s[32:35], s52 offen
    s_add_u32 s52, s52, 8192
    v_cvt_pk_bf16_f32 v22, v22, v22
    buffer_store_short v22, v5, s[32:35], s52 offen
    s_add_u32 s52, s52, 8192
    v_cvt_pk_bf16_f32 v23, v23, v23
    buffer_store_short v23, v5, s[32:35], s52 offen
    s_add_u32 s52, s52, 8192
K1_END:
    s_endpgm
.section .rodata,"a"
.p2align 6
.amdhsa_kernel k1_kernel
  .amdhsa_next_free_vgpr 128
  .amdhsa_next_free_sgpr 96
  .amdhsa_accum_offset 128
  .amdhsa_group_segment_fixed_size 0
  .amdhsa_kernarg_size 112
  .amdhsa_user_sgpr_count 2
  .amdhsa_user_sgpr_kernarg_segment_ptr 1
  .amdhsa_system_sgpr_workgroup_id_x 1
.end_amdhsa_kernel
.text
.globl k1b_kernel
.p2align 8
.type k1b_kernel,@function
k1b_kernel:
    s_cmp_ge_u32 s2, 256
    s_cbranch_scc1 K1B_END
    s_load_dwordx2 s[8:9], s[0:1], 24
    s_load_dwordx2 s[16:17], s[0:1], 104
    s_load_dwordx4 s[4:7], s[0:1], 32
    s_load_dwordx2 s[10:11], s[0:1], 72
    v_and_b32 v1, 63, v0
    v_lshrrev_b32 v2, 6, v0
    s_nop 0
    v_readfirstlane_b32 s3, v2
    v_lshrrev_b32 v3, 4, v1
    v_and_b32 v4, 15, v1
    s_waitcnt lgkmcnt(0)
    s_mov_b32 s28, s8
    s_and_b32 s29, s9, 0xffff
    s_mov_b32 s30, 4194304
    s_mov_b32 s31, 0x00020000
    s_mov_b32 s32, s16
    s_and_b32 s33, s17, 0xffff
    s_mov_b32 s34, 13631488
    s_mov_b32 s35, 0x00020000
    s_mov_b32 s64, s4
    s_and_b32 s65, s5, 0xffff
    s_mov_b32 s66, 4194304
    s_mov_b32 s67, 0x00020000
    s_mov_b32 s68, s6
    s_and_b32 s69, s7, 0xffff
    s_mov_b32 s70, 4194304
    s_mov_b32 s71, 0x00020000
    s_mov_b32 s72, s10
    s_and_b32 s73, s11, 0xffff
    s_mov_b32 s74, 1835008
    s_mov_b32 s75, 0x00020000
    s_and_b32 s42, s2, 31
    s_lshr_b32 s43, s2, 5
    v_lshlrev_b32 v11, 13, v4
    v_lshl_add_u32 v11, v3, 4, v11
    s_lshl_b32 s51, s43, 19
    s_lshl_b32 s52, s3, 17
    s_add_u32 s51, s51, s52
    s_lshl_b32 s52, s42, 8
    s_add_u32 s51, s51, s52
    buffer_load_dwordx4 v[32:35], v11, s[28:31], s51 offen offset:0
    buffer_load_dwordx4 v[36:39], v11, s[28:31], s51 offen offset:64
    buffer_load_dwordx4 v[40:43], v11, s[28:31], s51 offen offset:128
    buffer_load_dwordx4 v[44:47], v11, s[28:31], s51 offen offset:192
    v_and_b32 v5, 3, v1
    v_lshlrev_b32 v5, 13, v5
    v_lshl_add_u32 v5, v3, 4, v5
    s_add_u32 s52, s52, 262144
    buffer_load_dwordx4 v[48:51], v5, s[32:35], s52 offen offset:0
    buffer_load_dwordx4 v[52:55], v5, s[32:35], s52 offen offset:64
    buffer_load_dwordx4 v[56:59], v5, s[32:35], s52 offen offset:128
    buffer_load_dwordx4 v[60:63], v5, s[32:35], s52 offen offset:192
    v_lshlrev_b32 v6, 15, v4
    v_lshl_add_u32 v6, v3, 3, v6
    s_lshl_b32 s52, s42, 10
    s_lshl_b32 s53, s43, 7
    s_add_u32 s52, s52, s53
    s_lshl_b32 s53, s3, 5
    s_add_u32 s52, s52, s53
    v_cmp_gt_u32 vcc, 4, v4
    v_lshlrev_b32 v62, 4, v0
    s_lshl_b32 s76, s2, 14
    s_mul_i32 s77, s2, 7168
    s_waitcnt vmcnt(0)
    v_mfma_f32_16x16x32_bf16 v[20:23], v[32:35], v[48:51], 0
    v_mfma_f32_16x16x32_bf16 v[20:23], v[36:39], v[52:55], v[20:23]
    v_mfma_f32_16x16x32_bf16 v[20:23], v[40:43], v[56:59], v[20:23]
    v_mfma_f32_16x16x32_bf16 v[20:23], v[44:47], v[60:63], v[20:23]
    s_nop 7
    s_nop 3
    v_cvt_pk_bf16_f32 v20, v20, v21
    v_cvt_pk_bf16_f32 v21, v22, v23
    s_and_saveexec_b64 s[60:61], vcc
    buffer_store_dwordx2 v[20:21], v6, s[32:35], s52 offen
K1B_END:
    s_endpgm
.section .rodata,"a"
.p2align 6
.amdhsa_kernel k1b_kernel
  .amdhsa_next_free_vgpr 64
  .amdhsa_next_free_sgpr 96
  .amdhsa_accum_offset 64
  .amdhsa_group_segment_fixed_size 0
  .amdhsa_kernarg_size 112
  .amdhsa_user_sgpr_count 2
  .amdhsa_user_sgpr_kernarg_segment_ptr 1
  .amdhsa_system_sgpr_workgroup_id_x 1
.end_amdhsa_kernel
.text
.globl k2_kernel
.p2align 8
.type k2_kernel,@function
k2_kernel:
    s_cmp_ge_u32 s2, 256
    s_cbranch_scc1 K2_END
    s_load_dwordx2 s[4:5], s[0:1], 8
    s_load_dwordx2 s[16:17], s[0:1], 104
    v_and_b32 v1, 63, v0
    v_lshrrev_b32 v2, 6, v0
    s_nop 0
    v_readfirstlane_b32 s3, v2
    v_lshrrev_b32 v3, 4, v1
    v_and_b32 v4, 15, v1
    s_waitcnt lgkmcnt(0)
    s_mov_b32 s20, s4
    s_and_b32 s21, s5, 0xffff
    s_mov_b32 s22, 16777216
    s_mov_b32 s23, 0x00020000
    s_mov_b32 s32, s16
    s_and_b32 s33, s17, 0xffff
    s_mov_b32 s34, 13631488
    s_mov_b32 s35, 0x00020000
    s_lshr_b32 s40, s2, 6
    s_and_b32 s41, s2, 63
    s_lshl_b32 s42, s2, 16
    s_lshl_b32 s43, s3, 14
    s_add_u32 s42, s42, s43
    v_xor_b32 v8, 0, v1
    v_lshlrev_b32 v8, 4, v8
    s_add_u32 m0, s43, 0
    s_nop 0
    buffer_load_dwordx4 v8, s[20:23], s42 offen lds
    s_add_u32 s42, s42, 1024
    v_xor_b32 v8, 2, v1
    v_lshlrev_b32 v8, 4, v8
    s_add_u32 m0, s43, 1024
    s_nop 0
    buffer_load_dwordx4 v8, s[20:23], s42 offen lds
    s_add_u32 s42, s42, 1024
    v_xor_b32 v8, 4, v1
    v_lshlrev_b32 v8, 4, v8
    s_add_u32 m0, s43, 2048
    s_nop 0
    buffer_load_dwordx4 v8, s[20:23], s42 offen lds
    s_add_u32 s42, s42, 1024
    v_xor_b32 v8, 6, v1
    v_lshlrev_b32 v8, 4, v8
    s_add_u32 m0, s43, 3072
    s_nop 0
    buffer_load_dwordx4 v8, s[20:23], s42 offen lds
    s_add_u32 s42, s42, 1024
    v_xor_b32 v8, 8, v1
    v_lshlrev_b32 v8, 4, v8
    s_add_u32 m0, s43, 4096
    s_nop 0
    buffer_load_dwordx4 v8, s[20:23], s42 offen lds
    s_add_u32 s42, s42, 1024
    v_xor_b32 v8, 10, v1
    v_lshlrev_b32 v8, 4, v8
    s_add_u32 m0, s43, 5120
    s_nop 0
    buffer_load_dwordx4 v8, s[20:23], s42 offen lds
    s_add_u32 s42, s42, 1024
    v_xor_b32 v8, 12, v1
    v_lshlrev_b32 v8, 4, v8
    s_add_u32 m0, s43, 6144
    s_nop 0
    buffer_load_dwordx4 v8, s[20:23], s42 offen lds
    s_add_u32 s42, s42, 1024
    v_xor_b32 v8, 14, v1
    v_lshlrev_b32 v8, 4, v8
    s_add_u32 m0, s43, 7168
    s_nop 0
    buffer_load_dwordx4 v8, s[20:23], s42 offen lds
    s_add_u32 s42, s42, 1024
    v_xor_b32 v8, 1, v1
    v_lshlrev_b32 v8, 4, v8
    s_add_u32 m0, s43, 8192
    s_nop 0
    buffer_load_dwordx4 v8, s[20:23], s42 offen lds
    s_add_u32 s42, s42, 1024
    v_xor_b32 v8, 3, v1
    v_lshlrev_b32 v8, 4, v8
    s_add_u32 m0, s43, 9216
    s_nop 0
    buffer_load_dwordx4 v8, s[20:23], s42 offen lds
    s_add_u32 s42, s42, 1024
    v_xor_b32 v8, 5, v1
    v_lshlrev_b32 v8, 4, v8
    s_add_u32 m0, s43, 10240
    s_nop 0
    buffer_load_dwordx4 v8, s[20:23], s42 offen lds
    s_add_u32 s42, s42, 1024
    v_xor_b32 v8, 7, v1
    v_lshlrev_b32 v8, 4, v8
    s_add_u32 m0, s43, 11264
    s_nop 0
    buffer_load_dwordx4 v8, s[20:23], s42 offen lds
    s_add_u32 s42, s42, 1024
    v_xor_b32 v8, 9, v1
    v_lshlrev_b32 v8, 4, v8
    s_add_u32 m0, s43, 12288
    s_nop 0
    buffer_load_dwordx4 v8, s[20:23], s42 offen lds
    s_add_u32 s42, s42, 1024
    v_xor_b32 v8, 11, v1
    v_lshlrev_b32 v8, 4, v8
    s_add_u32 m0, s43, 13312
    s_nop 0
    buffer_load_dwordx4 v8, s[20:23], s42 offen lds
    s_add_u32 s42, s42, 1024
    v_xor_b32 v8, 13, v1
    v_lshlrev_b32 v8, 4, v8
    s_add_u32 m0, s43, 14336
    s_nop 0
    buffer_load_dwordx4 v8, s[20:23], s42 offen lds
    s_add_u32 s42, s42, 1024
    v_xor_b32 v8, 15, v1
    v_lshlrev_b32 v8, 4, v8
    s_add_u32 m0, s43, 15360
    s_nop 0
    buffer_load_dwordx4 v8, s[20:23], s42 offen lds
    s_add_u32 s42, s42, 1024
    v_lshlrev_b32 v9, 4, v1
    s_lshl_b32 s44, s40, 15
    s_lshl_b32 s45, s3, 13
    s_add_u32 s44, s44, s45
    s_mul_i32 s45, s3, 8320
    s_add_u32 s45, s45, 0x10000
    s_add_u32 m0, s45, 0
    s_nop 0
    buffer_load_dwordx4 v9, s[32:35], s44 offen lds
    s_add_u32 s44, s44, 1024
    s_add_u32 m0, s45, 1040
    s_nop 0
    buffer_load_dwordx4 v9, s[32:35], s44 offen lds
    s_add_u32 s44, s44, 1024
    s_add_u32 m0, s45, 2080
    s_nop 0
    buffer_load_dwordx4 v9, s[32:35], s44 offen lds
    s_add_u32 s44, s44, 1024
    s_add_u32 m0, s45, 3120
    s_nop 0
    buffer_load_dwordx4 v9, s[32:35], s44 offen lds
    s_add_u32 s44, s44, 1024
    s_add_u32 m0, s45, 4160
    s_nop 0
    buffer_load_dwordx4 v9, s[32:35], s44 offen lds
    s_add_u32 s44, s44, 1024
    s_add_u32 m0, s45, 5200
    s_nop 0
    buffer_load_dwordx4 v9, s[32:35], s44 offen lds
    s_add_u32 s44, s44, 1024
    s_add_u32 m0, s45, 6240
    s_nop 0
    buffer_load_dwordx4 v9, s[32:35], s44 offen lds
    s_add_u32 s44, s44, 1024
    s_add_u32 m0, s45, 7280
    s_nop 0
    buffer_load_dwordx4 v9, s[32:35], s44 offen lds
    s_add_u32 s44, s44, 1024
    v_and_b32 v12, 7, v4
    v_lshlrev_b32 v12, 1, v12
    v_lshrrev_b32 v13, 3, v4
    v_or_b32 v12, v12, v13
    v_lshlrev_b32 v13, 10, v4
    v_add_u32 v13, s43, v13
    v_add_u32 v14, 0, v3
    v_xor_b32 v14, v14, v12
    v_lshl_add_u32 v16, v14, 4, v13
    v_add_u32 v14, 4, v3
    v_xor_b32 v14, v14, v12
    v_lshl_add_u32 v17, v14, 4, v13
    v_add_u32 v14, 8, v3
    v_xor_b32 v14, v14, v12
    v_lshl_add_u32 v18, v14, 4, v13
    v_add_u32 v14, 12, v3
    v_xor_b32 v14, v14, v12
    v_lshl_add_u32 v19, v14, 4, v13
    v_mul_u32_u24 v20, 1040, v4
    v_lshl_add_u32 v20, v3, 4, v20
    v_add_u32 v20, 0x10000, v20
    v_mov_b32 v24, 0
    v_mov_b32 v25, 0
    v_mov_b32 v26, 0
    v_mov_b32 v27, 0
    v_mov_b32 v28, 0
    v_mov_b32 v29, 0
    v_mov_b32 v30, 0
    v_mov_b32 v31, 0
    s_waitcnt vmcnt(0) lgkmcnt(0)
    s_barrier
    ds_read_b128 v[96:99], v16 offset:0
    ds_read_b128 v[100:103], v20 offset:0
    ds_read_b128 v[104:107], v20 offset:16640
    ds_read_b128 v[108:111], v17 offset:0
    ds_read_b128 v[112:115], v20 offset:64
    ds_read_b128 v[116:119], v20 offset:16704
    ds_read_b128 v[120:123], v18 offset:0
    ds_read_b128 v[124:127], v20 offset:128
    ds_read_b128 v[128:131], v20 offset:16768
    s_waitcnt lgkmcnt(6)
    v_mfma_f32_16x16x32_bf16 v[24:27], v[96:99], v[100:103], v[24:27]
    v_mfma_f32_16x16x32_bf16 v[28:31], v[96:99], v[104:107], v[28:31]
    ds_read_b128 v[96:99], v19 offset:0
    ds_read_b128 v[100:103], v20 offset:192
    ds_read_b128 v[104:107], v20 offset:16832
    s_waitcnt lgkmcnt(6)
    v_mfma_f32_16x16x32_bf16 v[24:27], v[108:111], v[112:115], v[24:27]
    v_mfma_f32_16x16x32_bf16 v[28:31], v[108:111], v[116:119], v[28:31]
    ds_read_b128 v[108:111], v16 offset:256
    ds_read_b128 v[112:115], v20 offset:256
    ds_read_b128 v[116:119], v20 offset:16896
    s_waitcnt lgkmcnt(6)
    v_mfma_f32_16x16x32_bf16 v[24:27], v[120:123], v[124:127], v[24:27]
    v_mfma_f32_16x16x32_bf16 v[28:31], v[120:123], v[128:131], v[28:31]
    ds_read_b128 v[120:123], v17 offset:256
    ds_read_b128 v[124:127], v20 offset:320
    ds_read_b128 v[128:131], v20 offset:16960
    s_waitcnt lgkmcnt(6)
    v_mfma_f32_16x16x32_bf16 v[24:27], v[96:99], v[100:103], v[24:27]
    v_mfma_f32_16x16x32_bf16 v[28:31], v[96:99], v[104:107], v[28:31]
    ds_read_b128 v[96:99], v18 offset:256
    ds_read_b128 v[100:103], v20 offset:384
    ds_read_b128 v[104:107], v20 offset:17024
    s_waitcnt lgkmcnt(6)
    v_mfma_f32_16x16x32_bf16 v[24:27], v[108:111], v[112:115], v[24:27]
    v_mfma_f32_16x16x32_bf16 v[28:31], v[108:111], v[116:119], v[28:31]
    ds_read_b128 v[108:111], v19 offset:256
    ds_read_b128 v[112:115], v20 offset:448
    ds_read_b128 v[116:119], v20 offset:17088
    s_waitcnt lgkmcnt(6)
    v_mfma_f32_16x16x32_bf16 v[24:27], v[120:123], v[124:127], v[24:27]
    v_mfma_f32_16x16x32_bf16 v[28:31], v[120:123], v[128:131], v[28:31]
    ds_read_b128 v[120:123], v16 offset:512
    ds_read_b128 v[124:127], v20 offset:512
    ds_read_b128 v[128:131], v20 offset:17152
    s_waitcnt lgkmcnt(6)
    v_mfma_f32_16x16x32_bf16 v[24:27], v[96:99], v[100:103], v[24:27]
    v_mfma_f32_16x16x32_bf16 v[28:31], v[96:99], v[104:107], v[28:31]
    ds_read_b128 v[96:99], v17 offset:512
    ds_read_b128 v[100:103], v20 offset:576
    ds_read_b128 v[104:107], v20 offset:17216
    s_waitcnt lgkmcnt(6)
    v_mfma_f32_16x16x32_bf16 v[24:27], v[108:111], v[112:115], v[24:27]
    v_mfma_f32_16x16x32_bf16 v[28:31], v[108:111], v[116:119], v[28:31]
    ds_read_b128 v[108:111], v18 offset:512
    ds_read_b128 v[112:115], v20 offset:640
    ds_read_b128 v[116:119], v20 offset:17280
    s_waitcnt lgkmcnt(6)
    v_mfma_f32_16x16x32_bf16 v[24:27], v[120:123], v[124:127], v[24:27]
    v_mfma_f32_16x16x32_bf16 v[28:31], v[120:123], v[128:131], v[28:31]
    ds_read_b128 v[120:123], v19 offset:512
    ds_read_b128 v[124:127], v20 offset:704
    ds_read_b128 v[128:131], v20 offset:17344
    s_waitcnt lgkmcnt(6)
    v_mfma_f32_16x16x32_bf16 v[24:27], v[96:99], v[100:103], v[24:27]
    v_mfma_f32_16x16x32_bf16 v[28:31], v[96:99], v[104:107], v[28:31]
    ds_read_b128 v[96:99], v16 offset:768
    ds_read_b128 v[100:103], v20 offset:768
    ds_read_b128 v[104:107], v20 offset:17408
    s_waitcnt lgkmcnt(6)
    v_mfma_f32_16x16x32_bf16 v[24:27], v[108:111], v[112:115], v[24:27]
    v_mfma_f32_16x16x32_bf16 v[28:31], v[108:111], v[116:119], v[28:31]
    ds_read_b128 v[108:111], v17 offset:768
    ds_read_b128 v[112:115], v20 offset:832
    ds_read_b128 v[116:119], v20 offset:17472
    s_waitcnt lgkmcnt(6)
    v_mfma_f32_16x16x32_bf16 v[24:27], v[120:123], v[124:127], v[24:27]
    v_mfma_f32_16x16x32_bf16 v[28:31], v[120:123], v[128:131], v[28:31]
    ds_read_b128 v[120:123], v18 offset:768
    ds_read_b128 v[124:127], v20 offset:896
    ds_read_b128 v[128:131], v20 offset:17536
    s_waitcnt lgkmcnt(6)
    v_mfma_f32_16x16x32_bf16 v[24:27], v[96:99], v[100:103], v[24:27]
    v_mfma_f32_16x16x32_bf16 v[28:31], v[96:99], v[104:107], v[28:31]
    ds_read_b128 v[96:99], v19 offset:768
    ds_read_b128 v[100:103], v20 offset:960
    ds_read_b128 v[104:107], v20 offset:17600
    s_waitcnt lgkmcnt(6)
    v_mfma_f32_16x16x32_bf16 v[24:27], v[108:111], v[112:115], v[24:27]
    v_mfma_f32_16x16x32_bf16 v[28:31], v[108:111], v[116:119], v[28:31]
    s_waitcnt lgkmcnt(3)
    v_mfma_f32_16x16x32_bf16 v[24:27], v[120:123], v[124:127], v[24:27]
    v_mfma_f32_16x16x32_bf16 v[28:31], v[120:123], v[128:131], v[28:31]
    s_waitcnt lgkmcnt(0)
    v_mfma_f32_16x16x32_bf16 v[24:27], v[96:99], v[100:103], v[24:27]
    v_mfma_f32_16x16x32_bf16 v[28:31], v[96:99], v[104:107], v[28:31]
    s_nop 7
    s_nop 3
    v_mov_b32 v21, s3
    v_lshl_add_u32 v21, v21, 2, v3
    v_lshlrev_b32 v21, 2, v21
    v_lshl_add_u32 v21, v4, 6, v21
    v_add_u32 v21, 0x18200, v21
    v_lshlrev_b32 v22, 6, v4
    v_add_u32 v22, 0x18200, v22
    v_max_f32 v32, v24, v25
    v_max3_f32 v32, v32, v26, v27
    ds_write_b32 v21, v32 offset:0
    v_max_f32 v32, v28, v29
    v_max3_f32 v32, v32, v30, v31
    ds_write_b32 v21, v32 offset:1024
    s_waitcnt lgkmcnt(0)
    s_barrier
    s_mov_b32 s46, 0x3e0293ee
    s_lshr_b32 s47, s3, 1
    s_lshl_b32 s47, s47, 6
    s_and_b32 s48, s3, 1
    s_lshl_b32 s48, s48, 3
    s_add_u32 s47, s47, s48
    v_mul_u32_u24 v23, 144, v4
    v_lshl_add_u32 v23, v3, 4, v23
    v_add_u32 v23, s47, v23
    v_add_u32 v23, 0x19200, v23
    ds_read_b128 v[32:35], v22 offset:0
    ds_read_b128 v[36:39], v22 offset:16
    ds_read_b128 v[40:43], v22 offset:32
    ds_read_b128 v[44:47], v22 offset:48
    s_waitcnt lgkmcnt(0)
    v_max3_f32 v32, v32, v33, v34
    v_max3_f32 v32, v32, v35, v36
    v_max3_f32 v32, v32, v37, v38
    v_max3_f32 v32, v32, v39, v40
    v_max3_f32 v32, v32, v41, v42
    v_max3_f32 v32, v32, v43, v44
    v_max3_f32 v32, v32, v45, v46
    v_max_f32 v32, v32, v47
    v_mul_f32 v56, s46, v32
    v_fma_f32 v24, v24, s46, -v56
    v_exp_f32 v24, v24
    v_fma_f32 v25, v25, s46, -v56
    v_exp_f32 v25, v25
    v_fma_f32 v26, v26, s46, -v56
    v_exp_f32 v26, v26
    v_fma_f32 v27, v27, s46, -v56
    v_exp_f32 v27, v27
    s_nop 0
    v_add_f32 v33, v24, v25
    v_add_f32 v34, v26, v27
    v_add_f32 v33, v33, v34
    ds_write_b32 v21, v33 offset:2048
    v_cvt_pk_bf16_f32 v34, v24, v25
    v_cvt_pk_bf16_f32 v35, v26, v27
    ds_write_b64 v23, v[34:35] offset:0
    ds_read_b128 v[32:35], v22 offset:1024
    ds_read_b128 v[36:39], v22 offset:1040
    ds_read_b128 v[40:43], v22 offset:1056
    ds_read_b128 v[44:47], v22 offset:1072
    s_waitcnt lgkmcnt(0)
    v_max3_f32 v32, v32, v33, v34
    v_max3_f32 v32, v32, v35, v36
    v_max3_f32 v32, v32, v37, v38
    v_max3_f32 v32, v32, v39, v40
    v_max3_f32 v32, v32, v41, v42
    v_max3_f32 v32, v32, v43, v44
    v_max3_f32 v32, v32, v45, v46
    v_max_f32 v32, v32, v47
    v_mul_f32 v57, s46, v32
    v_fma_f32 v28, v28, s46, -v57
    v_exp_f32 v28, v28
    v_fma_f32 v29, v29, s46, -v57
    v_exp_f32 v29, v29
    v_fma_f32 v30, v30, s46, -v57
    v_exp_f32 v30, v30
    v_fma_f32 v31, v31, s46, -v57
    v_exp_f32 v31, v31
    s_nop 0
    v_add_f32 v33, v28, v29
    v_add_f32 v34, v30, v31
    v_add_f32 v33, v33, v34
    ds_write_b32 v21, v33 offset:3072
    v_cvt_pk_bf16_f32 v34, v28, v29
    v_cvt_pk_bf16_f32 v35, v30, v31
    ds_write_b64 v23, v[34:35] offset:2304
    s_waitcnt lgkmcnt(0)
    s_barrier
    s_cmp_lg_u32 s3, 0
    s_cbranch_scc1 K2_PV
    v_cmp_gt_u32 vcc, 16, v1
    s_and_saveexec_b64 s[60:61], vcc
    v_lshlrev_b32 v48, 10, v4
    s_lshl_b32 s47, s40, 8
    s_lshl_b32 s48, s41, 2
    s_add_u32 s47, s47, s48
    s_add_u32 s48, s47, 10485760
    s_add_u32 s49, s47, 10518528
    ds_read_b128 v[32:35], v22 offset:2048
    ds_read_b128 v[36:39], v22 offset:2064
    ds_read_b128 v[40:43], v22 offset:2080
    ds_read_b128 v[44:47], v22 offset:2096
    s_waitcnt lgkmcnt(0)
    v_add_f32 v32, v32, v33
    v_add_f32 v32, v32, v34
    v_add_f32 v32, v32, v35
    v_add_f32 v32, v32, v36
    v_add_f32 v32, v32, v37
    v_add_f32 v32, v32, v38
    v_add_f32 v32, v32, v39
    v_add_f32 v32, v32, v40
    v_add_f32 v32, v32, v41
    v_add_f32 v32, v32, v42
    v_add_f32 v32, v32, v43
    v_add_f32 v32, v32, v44
    v_add_f32 v32, v32, v45
    v_add_f32 v32, v32, v46
    v_add_f32 v32, v32, v47
    buffer_store_dword v56, v48, s[32:35], s48 offen
    buffer_store_dword v32, v48, s[32:35], s49 offen
    s_add_u32 s48, s48, 16384
    s_add_u32 s49, s49, 16384
    ds_read_b128 v[32:35], v22 offset:3072
    ds_read_b128 v[36:39], v22 offset:3088
    ds_read_b128 v[40:43], v22 offset:3104
    ds_read_b128 v[44:47], v22 offset:3120
    s_waitcnt lgkmcnt(0)
    v_add_f32 v32, v32, v33
    v_add_f32 v32, v32, v34
    v_add_f32 v32, v32, v35
    v_add_f32 v32, v32, v36
    v_add_f32 v32, v32, v37
    v_add_f32 v32, v32, v38
    v_add_f32 v32, v32, v39
    v_add_f32 v32, v32, v40
    v_add_f32 v32, v32, v41
    v_add_f32 v32, v32, v42
    v_add_f32 v32, v32, v43
    v_add_f32 v32, v32, v44
    v_add_f32 v32, v32, v45
    v_add_f32 v32, v32, v46
    v_add_f32 v32, v32, v47
    buffer_store_dword v57, v48, s[32:35], s48 offen
    buffer_store_dword v32, v48, s[32:35], s49 offen
    s_add_u32 s48, s48, 16384
    s_add_u32 s49, s49, 16384
    s_mov_b64 exec, s[60:61]
K2_PV:
    v_mul_u32_u24 v23, 144, v4
    v_lshl_add_u32 v23, v3, 4, v23
    v_add_u32 v23, 0x19200, v23
    ds_read_b128 v[32:35], v23 offset:0
    ds_read_b128 v[36:39], v23 offset:64
    ds_read_b128 v[40:43], v23 offset:2304
    ds_read_b128 v[44:47], v23 offset:2368
    v_lshrrev_b32 v49, 2, v4
    v_lshl_add_u32 v49, v3, 2, v49
    v_and_b32 v50, 7, v49
    v_lshlrev_b32 v50, 1, v50
    v_lshrrev_b32 v51, 3, v49
    v_or_b32 v50, v50, v51
    v_bfe_u32 v51, v4, 1, 1
    v_xor_b32 v50, v50, v51
    v_lshlrev_b32 v48, 10, v49
    v_lshl_add_u32 v48, v50, 4, v48
    v_and_b32 v51, 1, v4
    v_lshl_add_u32 v48, v51, 3, v48
    s_lshl_b32 s47, s3, 8
    v_add_u32 v48, s47, v48
    v_mul_u32_u24 v49, 1040, v4
    v_lshl_add_u32 v49, v3, 3, v49
    v_add_u32 v49, s47, v49
    v_add_u32 v49, 0x10000, v49
    v_xor_b32 v50, 0, v48
    ds_read_b64_tr_b16 v[128:129], v50 offset:0
    ds_read_b64_tr_b16 v[130:131], v50 offset:16384
    ds_read_b64_tr_b16 v[132:133], v50 offset:32768
    ds_read_b64_tr_b16 v[134:135], v50 offset:49152
    v_xor_b32 v50, 32, v48
    ds_read_b64_tr_b16 v[136:137], v50 offset:0
    ds_read_b64_tr_b16 v[138:139], v50 offset:16384
    ds_read_b64_tr_b16 v[140:141], v50 offset:32768
    ds_read_b64_tr_b16 v[142:143], v50 offset:49152
    v_xor_b32 v50, 64, v48
    ds_read_b64_tr_b16 v[144:145], v50 offset:0
    ds_read_b64_tr_b16 v[146:147], v50 offset:16384
    ds_read_b64_tr_b16 v[148:149], v50 offset:32768
    ds_read_b64_tr_b16 v[150:151], v50 offset:49152
    s_waitcnt lgkmcnt(8)
    v_xor_b32 v50, 96, v48
    ds_read_b64_tr_b16 v[152:153], v50 offset:0
    ds_read_b64_tr_b16 v[154:155], v50 offset:16384
    ds_read_b64_tr_b16 v[156:157], v50 offset:32768
    ds_read_b64_tr_b16 v[158:159], v50 offset:49152
    v_xor_b32 v50, 128, v48
    ds_read_b64_tr_b16 v[160:161], v50 offset:0
    ds_read_b64_tr_b16 v[162:163], v50 offset:16384
    ds_read_b64_tr_b16 v[164:165], v50 offset:32768
    ds_read_b64_tr_b16 v[166:167], v50 offset:49152
    v_xor_b32 v50, 160, v48
    ds_read_b64_tr_b16 v[168:169], v50 offset:0
    ds_read_b64_tr_b16 v[170:171], v50 offset:16384
    ds_read_b64_tr_b16 v[172:173], v50 offset:32768
    ds_read_b64_tr_b16 v[174:175], v50 offset:49152
    s_waitcnt lgkmcnt(8)
    v_xor_b32 v50, 192, v48
    ds_read_b64_tr_b16 v[176:177], v50 offset:0
    ds_read_b64_tr_b16 v[178:179], v50 offset:16384
    ds_read_b64_tr_b16 v[180:181], v50 offset:32768
    ds_read_b64_tr_b16 v[182:183], v50 offset:49152
    v_xor_b32 v50, 224, v48
    ds_read_b64_tr_b16 v[184:185], v50 offset:0
    ds_read_b64_tr_b16 v[186:187], v50 offset:16384
    ds_read_b64_tr_b16 v[188:189], v50 offset:32768
    ds_read_b64_tr_b16 v[190:191], v50 offset:49152
    s_waitcnt lgkmcnt(15)
    v_mfma_f32_16x16x32_bf16 v[64:67], v[128:131], v[32:35], 0
    v_mfma_f32_16x16x32_bf16 v[64:67], v[132:135], v[36:39], v[64:67]
    v_mfma_f32_16x16x32_bf16 v[68:71], v[128:131], v[40:43], 0
    v_mfma_f32_16x16x32_bf16 v[68:71], v[132:135], v[44:47], v[68:71]
    s_waitcnt lgkmcnt(15)
    v_mfma_f32_16x16x32_bf16 v[72:75], v[136:139], v[32:35], 0
    v_mfma_f32_16x16x32_bf16 v[72:75], v[140:143], v[36:39], v[72:75]
    v_mfma_f32_16x16x32_bf16 v[76:79], v[136:139], v[40:43], 0
    v_mfma_f32_16x16x32_bf16 v[76:79], v[140:143], v[44:47], v[76:79]
    s_waitcnt lgkmcnt(15)
    v_mfma_f32_16x16x32_bf16 v[80:83], v[144:147], v[32:35], 0
    v_mfma_f32_16x16x32_bf16 v[80:83], v[148:151], v[36:39], v[80:83]
    v_mfma_f32_16x16x32_bf16 v[84:87], v[144:147], v[40:43], 0
    v_mfma_f32_16x16x32_bf16 v[84:87], v[148:151], v[44:47], v[84:87]
    s_waitcnt lgkmcnt(15)
    v_mfma_f32_16x16x32_bf16 v[88:91], v[152:155], v[32:35], 0
    v_mfma_f32_16x16x32_bf16 v[88:91], v[156:159], v[36:39], v[88:91]
    v_mfma_f32_16x16x32_bf16 v[92:95], v[152:155], v[40:43], 0
    v_mfma_f32_16x16x32_bf16 v[92:95], v[156:159], v[44:47], v[92:95]
    s_waitcnt lgkmcnt(12)
    v_mfma_f32_16x16x32_bf16 v[96:99], v[160:163], v[32:35], 0
    v_mfma_f32_16x16x32_bf16 v[96:99], v[164:167], v[36:39], v[96:99]
    v_mfma_f32_16x16x32_bf16 v[100:103], v[160:163], v[40:43], 0
    v_mfma_f32_16x16x32_bf16 v[100:103], v[164:167], v[44:47], v[100:103]
    s_waitcnt lgkmcnt(8)
    v_mfma_f32_16x16x32_bf16 v[104:107], v[168:171], v[32:35], 0
    v_mfma_f32_16x16x32_bf16 v[104:107], v[172:175], v[36:39], v[104:107]
    v_mfma_f32_16x16x32_bf16 v[108:111], v[168:171], v[40:43], 0
    v_mfma_f32_16x16x32_bf16 v[108:111], v[172:175], v[44:47], v[108:111]
    s_waitcnt lgkmcnt(4)
    v_mfma_f32_16x16x32_bf16 v[112:115], v[176:179], v[32:35], 0
    v_mfma_f32_16x16x32_bf16 v[112:115], v[180:183], v[36:39], v[112:115]
    v_mfma_f32_16x16x32_bf16 v[116:119], v[176:179], v[40:43], 0
    v_mfma_f32_16x16x32_bf16 v[116:119], v[180:183], v[44:47], v[116:119]
    s_waitcnt lgkmcnt(0)
    v_mfma_f32_16x16x32_bf16 v[120:123], v[184:187], v[32:35], 0
    v_mfma_f32_16x16x32_bf16 v[120:123], v[188:191], v[36:39], v[120:123]
    v_mfma_f32_16x16x32_bf16 v[124:127], v[184:187], v[40:43], 0
    v_mfma_f32_16x16x32_bf16 v[124:127], v[188:191], v[44:47], v[124:127]
    s_nop 7
    s_nop 3
    v_cvt_pk_bf16_f32 v64, v64, v65
    v_cvt_pk_bf16_f32 v65, v66, v67
    ds_write_b64 v49, v[64:65] offset:0
    v_cvt_pk_bf16_f32 v68, v68, v69
    v_cvt_pk_bf16_f32 v69, v70, v71
    ds_write_b64 v49, v[68:69] offset:16640
    v_cvt_pk_bf16_f32 v72, v72, v73
    v_cvt_pk_bf16_f32 v73, v74, v75
    ds_write_b64 v49, v[72:73] offset:32
    v_cvt_pk_bf16_f32 v76, v76, v77
    v_cvt_pk_bf16_f32 v77, v78, v79
    ds_write_b64 v49, v[76:77] offset:16672
    v_cvt_pk_bf16_f32 v80, v80, v81
    v_cvt_pk_bf16_f32 v81, v82, v83
    ds_write_b64 v49, v[80:81] offset:64
    v_cvt_pk_bf16_f32 v84, v84, v85
    v_cvt_pk_bf16_f32 v85, v86, v87
    ds_write_b64 v49, v[84:85] offset:16704
    v_cvt_pk_bf16_f32 v88, v88, v89
    v_cvt_pk_bf16_f32 v89, v90, v91
    ds_write_b64 v49, v[88:89] offset:96
    v_cvt_pk_bf16_f32 v92, v92, v93
    v_cvt_pk_bf16_f32 v93, v94, v95
    ds_write_b64 v49, v[92:93] offset:16736
    v_cvt_pk_bf16_f32 v96, v96, v97
    v_cvt_pk_bf16_f32 v97, v98, v99
    ds_write_b64 v49, v[96:97] offset:128
    v_cvt_pk_bf16_f32 v100, v100, v101
    v_cvt_pk_bf16_f32 v101, v102, v103
    ds_write_b64 v49, v[100:101] offset:16768
    v_cvt_pk_bf16_f32 v104, v104, v105
    v_cvt_pk_bf16_f32 v105, v106, v107
    ds_write_b64 v49, v[104:105] offset:160
    v_cvt_pk_bf16_f32 v108, v108, v109
    v_cvt_pk_bf16_f32 v109, v110, v111
    ds_write_b64 v49, v[108:109] offset:16800
    v_cvt_pk_bf16_f32 v112, v112, v113
    v_cvt_pk_bf16_f32 v113, v114, v115
    ds_write_b64 v49, v[112:113] offset:192
    v_cvt_pk_bf16_f32 v116, v116, v117
    v_cvt_pk_bf16_f32 v117, v118, v119
    ds_write_b64 v49, v[116:117] offset:16832
    v_cvt_pk_bf16_f32 v120, v120, v121
    v_cvt_pk_bf16_f32 v121, v122, v123
    ds_write_b64 v49, v[120:121] offset:224
    v_cvt_pk_bf16_f32 v124, v124, v125
    v_cvt_pk_bf16_f32 v125, v126, v127
    ds_write_b64 v49, v[124:125] offset:16864
    s_waitcnt lgkmcnt(0)
    s_barrier
    v_lshrrev_b32 v50, 6, v0
    v_mul_u32_u24 v51, 1040, v50
    v_lshl_add_u32 v51, v1, 4, v51
    v_add_u32 v51, 0x10000, v51
    v_lshlrev_b32 v52, 18, v50
    v_lshrrev_b32 v53, 3, v1
    v_lshl_add_u32 v52, v53, 15, v52
    v_and_b32 v53, 7, v1
    v_lshl_add_u32 v52, v53, 4, v52
    s_lshl_b32 s47, s40, 13
    s_lshl_b32 s48, s41, 7
    s_add_u32 s47, s47, s48
    s_add_u32 s47, s47, 1048576
    ds_read_b128 v[64:67], v51 offset:0
    ds_read_b128 v[68:71], v51 offset:4160
    ds_read_b128 v[72:75], v51 offset:8320
    ds_read_b128 v[76:79], v51 offset:12480
    ds_read_b128 v[80:83], v51 offset:16640
    ds_read_b128 v[84:87], v51 offset:20800
    ds_read_b128 v[88:91], v51 offset:24960
    ds_read_b128 v[92:95], v51 offset:29120
    s_waitcnt lgkmcnt(7)
    buffer_store_dwordx4 v[64:67], v52, s[32:35], s47 offen
    s_add_u32 s47, s47, 0x100000
    s_waitcnt lgkmcnt(6)
    buffer_store_dwordx4 v[68:71], v52, s[32:35], s47 offen
    s_add_u32 s47, s47, 0x100000
    s_waitcnt lgkmcnt(5)
    buffer_store_dwordx4 v[72:75], v52, s[32:35], s47 offen
    s_add_u32 s47, s47, 0x100000
    s_waitcnt lgkmcnt(4)
    buffer_store_dwordx4 v[76:79], v52, s[32:35], s47 offen
    s_add_u32 s47, s47, 0x100000
    s_waitcnt lgkmcnt(3)
    buffer_store_dwordx4 v[80:83], v52, s[32:35], s47 offen
    s_add_u32 s47, s47, 0x100000
    s_waitcnt lgkmcnt(2)
    buffer_store_dwordx4 v[84:87], v52, s[32:35], s47 offen
    s_add_u32 s47, s47, 0x100000
    s_waitcnt lgkmcnt(1)
    buffer_store_dwordx4 v[88:91], v52, s[32:35], s47 offen
    s_add_u32 s47, s47, 0x100000
    s_waitcnt lgkmcnt(0)
    buffer_store_dwordx4 v[92:95], v52, s[32:35], s47 offen
    s_add_u32 s47, s47, 0x100000
K2_END:
    s_endpgm
.section .rodata,"a"
.p2align 6
.amdhsa_kernel k2_kernel
  .amdhsa_next_free_vgpr 192
  .amdhsa_next_free_sgpr 96
  .amdhsa_accum_offset 192
  .amdhsa_group_segment_fixed_size 0
  .amdhsa_kernarg_size 112
  .amdhsa_user_sgpr_count 2
  .amdhsa_user_sgpr_kernarg_segment_ptr 1
  .amdhsa_system_sgpr_workgroup_id_x 1
.end_amdhsa_kernel
.text
.globl k3_kernel
.p2align 8
.type k3_kernel,@function
k3_kernel:
    s_cmp_ge_u32 s2, 256
    s_cbranch_scc1 K3_END
    s_load_dwordx2 s[4:5], s[0:1], 32
    s_load_dwordx2 s[16:17], s[0:1], 104
    v_and_b32 v1, 63, v0
    v_lshrrev_b32 v2, 6, v0
    s_nop 0
    v_readfirstlane_b32 s3, v2
    v_lshrrev_b32 v3, 4, v1
    v_and_b32 v4, 15, v1
    s_waitcnt lgkmcnt(0)
    s_mov_b32 s20, s4
    s_and_b32 s21, s5, 0xffff
    s_mov_b32 s22, 4194304
    s_mov_b32 s23, 0x00020000
    s_mov_b32 s32, s16
    s_and_b32 s33, s17, 0xffff
    s_mov_b32 s34, 13631488
    s_mov_b32 s35, 0x00020000
    s_and_b32 s40, s2, 31
    s_lshr_b32 s41, s2, 5
    s_lshl_b32 s42, s41, 19
    s_lshl_b32 s44, s40, 8
    s_add_u32 s42, s42, s44
    s_lshl_b32 s44, s3, 17
    s_add_u32 s42, s42, s44
    s_lshl_b32 s43, s3, 12
    v_add_u32 v8, 0, v3
    v_and_b32 v9, 7, v8
    v_lshlrev_b32 v9, 1, v9
    v_lshrrev_b32 v10, 3, v8
    v_or_b32 v9, v9, v10
    v_xor_b32 v9, v9, v4
    v_lshlrev_b32 v9, 4, v9
    v_lshl_add_u32 v9, v8, 13, v9
    s_add_u32 m0, s43, 0
    s_nop 0
    buffer_load_dwordx4 v9, s[20:23], s42 offen lds
    v_add_u32 v8, 4, v3
    v_and_b32 v9, 7, v8
    v_lshlrev_b32 v9, 1, v9
    v_lshrrev_b32 v10, 3, v8
    v_or_b32 v9, v9, v10
    v_xor_b32 v9, v9, v4
    v_lshlrev_b32 v9, 4, v9
    v_lshl_add_u32 v9, v8, 13, v9
    s_add_u32 m0, s43, 1024
    s_nop 0
    buffer_load_dwordx4 v9, s[20:23], s42 offen lds
    v_add_u32 v8, 8, v3
    v_and_b32 v9, 7, v8
    v_lshlrev_b32 v9, 1, v9
    v_lshrrev_b32 v10, 3, v8
    v_or_b32 v9, v9, v10
    v_xor_b32 v9, v9, v4
    v_lshlrev_b32 v9, 4, v9
    v_lshl_add_u32 v9, v8, 13, v9
    s_add_u32 m0, s43, 2048
    s_nop 0
    buffer_load_dwordx4 v9, s[20:23], s42 offen lds
    v_add_u32 v8, 12, v3
    v_and_b32 v9, 7, v8
    v_lshlrev_b32 v9, 1, v9
    v_lshrrev_b32 v10, 3, v8
    v_or_b32 v9, v9, v10
    v_xor_b32 v9, v9, v4
    v_lshlrev_b32 v9, 4, v9
    v_lshl_add_u32 v9, v8, 13, v9
    s_add_u32 m0, s43, 3072
    s_nop 0
    buffer_load_dwordx4 v9, s[20:23], s42 offen lds
    v_lshrrev_b32 v10, 5, v1
    v_lshlrev_b32 v10, 12, v10
    v_and_b32 v11, 31, v1
    v_lshl_add_u32 v10, v11, 2, v10
    s_lshl_b32 s44, s40, 3
    s_add_u32 s44, s44, s41
    s_lshl_b32 s44, s44, 2
    s_add_u32 s44, s44, s3
    s_lshl_b32 s44, s44, 13
    s_add_u32 s44, s44, 1048576
    buffer_load_dword v64, v10, s[32:35], s44 offen offset:0
    buffer_load_dword v65, v10, s[32:35], s44 offen offset:128
    buffer_load_dword v66, v10, s[32:35], s44 offen offset:256
    buffer_load_dword v67, v10, s[32:35], s44 offen offset:384
    buffer_load_dword v68, v10, s[32:35], s44 offen offset:512
    buffer_load_dword v69, v10, s[32:35], s44 offen offset:640
    buffer_load_dword v70, v10, s[32:35], s44 offen offset:768
    buffer_load_dword v71, v10, s[32:35], s44 offen offset:896
    buffer_load_dword v72, v10, s[32:35], s44 offen offset:1024
    buffer_load_dword v73, v10, s[32:35], s44 offen offset:1152
    buffer_load_dword v74, v10, s[32:35], s44 offen offset:1280
    buffer_load_dword v75, v10, s[32:35], s44 offen offset:1408
    buffer_load_dword v76, v10, s[32:35], s44 offen offset:1536
    buffer_load_dword v77, v10, s[32:35], s44 offen offset:1664
    buffer_load_dword v78, v10, s[32:35], s44 offen offset:1792
    buffer_load_dword v79, v10, s[32:35], s44 offen offset:1920
    buffer_load_dword v80, v10, s[32:35], s44 offen offset:2048
    buffer_load_dword v81, v10, s[32:35], s44 offen offset:2176
    buffer_load_dword v82, v10, s[32:35], s44 offen offset:2304
    buffer_load_dword v83, v10, s[32:35], s44 offen offset:2432
    buffer_load_dword v84, v10, s[32:35], s44 offen offset:2560
    buffer_load_dword v85, v10, s[32:35], s44 offen offset:2688
    buffer_load_dword v86, v10, s[32:35], s44 offen offset:2816
    buffer_load_dword v87, v10, s[32:35], s44 offen offset:2944
    buffer_load_dword v88, v10, s[32:35], s44 offen offset:3072
    buffer_load_dword v89, v10, s[32:35], s44 offen offset:3200
    buffer_load_dword v90, v10, s[32:35], s44 offen offset:3328
    buffer_load_dword v91, v10, s[32:35], s44 offen offset:3456
    buffer_load_dword v92, v10, s[32:35], s44 offen offset:3584
    buffer_load_dword v93, v10, s[32:35], s44 offen offset:3712
    buffer_load_dword v94, v10, s[32:35], s44 offen offset:3840
    buffer_load_dword v95, v10, s[32:35], s44 offen offset:3968
    v_lshlrev_b32 v12, 2, v1
    s_lshl_b32 s44, s40, 10
    s_lshl_b32 s45, s3, 8
    s_add_u32 s44, s44, s45
    s_add_u32 s45, s44, 10485760
    s_add_u32 s44, s44, 10518528
    buffer_load_dword v13, v12, s[32:35], s45 offen
    buffer_load_dword v14, v12, s[32:35], s44 offen
    s_waitcnt vmcnt(0)
    v_mov_b32 v15, v13
    v_xor_b32 v17, 1, v1
    v_lshlrev_b32 v17, 2, v17
    ds_bpermute_b32 v16, v17, v15
    s_waitcnt lgkmcnt(0)
    v_max_f32 v15, v15, v16
    v_xor_b32 v17, 2, v1
    v_lshlrev_b32 v17, 2, v17
    ds_bpermute_b32 v16, v17, v15
    s_waitcnt lgkmcnt(0)
    v_max_f32 v15, v15, v16
    v_xor_b32 v17, 4, v1
    v_lshlrev_b32 v17, 2, v17
    ds_bpermute_b32 v16, v17, v15
    s_waitcnt lgkmcnt(0)
    v_max_f32 v15, v15, v16
    v_xor_b32 v17, 8, v1
    v_lshlrev_b32 v17, 2, v17
    ds_bpermute_b32 v16, v17, v15
    s_waitcnt lgkmcnt(0)
    v_max_f32 v15, v15, v16
    v_xor_b32 v17, 16, v1
    v_lshlrev_b32 v17, 2, v17
    ds_bpermute_b32 v16, v17, v15
    s_waitcnt lgkmcnt(0)
    v_max_f32 v15, v15, v16
    v_xor_b32 v17, 32, v1
    v_lshlrev_b32 v17, 2, v17
    ds_bpermute_b32 v16, v17, v15
    s_waitcnt lgkmcnt(0)
    v_max_f32 v15, v15, v16
    v_sub_f32 v13, v13, v15
    v_exp_f32 v13, v13
    s_nop 0
    v_mul_f32 v14, v14, v13
    v_xor_b32 v17, 1, v1
    v_lshlrev_b32 v17, 2, v17
    ds_bpermute_b32 v16, v17, v14
    s_waitcnt lgkmcnt(0)
    v_add_f32 v14, v14, v16
    v_xor_b32 v17, 2, v1
    v_lshlrev_b32 v17, 2, v17
    ds_bpermute_b32 v16, v17, v14
    s_waitcnt lgkmcnt(0)
    v_add_f32 v14, v14, v16
    v_xor_b32 v17, 4, v1
    v_lshlrev_b32 v17, 2, v17
    ds_bpermute_b32 v16, v17, v14
    s_waitcnt lgkmcnt(0)
    v_add_f32 v14, v14, v16
    v_xor_b32 v17, 8, v1
    v_lshlrev_b32 v17, 2, v17
    ds_bpermute_b32 v16, v17, v14
    s_waitcnt lgkmcnt(0)
    v_add_f32 v14, v14, v16
    v_xor_b32 v17, 16, v1
    v_lshlrev_b32 v17, 2, v17
    ds_bpermute_b32 v16, v17, v14
    s_waitcnt lgkmcnt(0)
    v_add_f32 v14, v14, v16
    v_xor_b32 v17, 32, v1
    v_lshlrev_b32 v17, 2, v17
    ds_bpermute_b32 v16, v17, v14
    s_waitcnt lgkmcnt(0)
    v_add_f32 v14, v14, v16
    v_rcp_f32 v14, v14
    s_nop 0
    v_mul_f32 v13, v13, v14
    s_lshl_b32 s44, s3, 8
    s_add_u32 s44, s44, 0x4000
    v_add_u32 v12, s44, v12
    ds_write_b32 v12, v13
    v_lshrrev_b32 v12, 5, v1
    v_lshlrev_b32 v12, 7, v12
    v_add_u32 v12, s44, v12
    s_waitcnt lgkmcnt(0)
    ds_read_b128 v[96:99], v12 offset:0
    ds_read_b128 v[100:103], v12 offset:16
    ds_read_b128 v[104:107], v12 offset:32
    ds_read_b128 v[108:111], v12 offset:48
    ds_read_b128 v[112:115], v12 offset:64
    ds_read_b128 v[116:119], v12 offset:80
    ds_read_b128 v[120:123], v12 offset:96
    ds_read_b128 v[124:127], v12 offset:112
    v_mov_b32 v20, 0
    v_mov_b32 v21, 0
    s_waitcnt lgkmcnt(0)
    v_lshlrev_b32 v22, 16, v64
    v_and_b32 v23, 0xffff0000, v64
    v_fmac_f32 v20, v22, v96
    v_fmac_f32 v21, v23, v96
    v_lshlrev_b32 v22, 16, v65
    v_and_b32 v23, 0xffff0000, v65
    v_fmac_f32 v20, v22, v97
    v_fmac_f32 v21, v23, v97
    v_lshlrev_b32 v22, 16, v66
    v_and_b32 v23, 0xffff0000, v66
    v_fmac_f32 v20, v22, v98
    v_fmac_f32 v21, v23, v98
    v_lshlrev_b32 v22, 16, v67
    v_and_b32 v23, 0xffff0000, v67
    v_fmac_f32 v20, v22, v99
    v_fmac_f32 v21, v23, v99
    v_lshlrev_b32 v22, 16, v68
    v_and_b32 v23, 0xffff0000, v68
    v_fmac_f32 v20, v22, v100
    v_fmac_f32 v21, v23, v100
    v_lshlrev_b32 v22, 16, v69
    v_and_b32 v23, 0xffff0000, v69
    v_fmac_f32 v20, v22, v101
    v_fmac_f32 v21, v23, v101
    v_lshlrev_b32 v22, 16, v70
    v_and_b32 v23, 0xffff0000, v70
    v_fmac_f32 v20, v22, v102
    v_fmac_f32 v21, v23, v102
    v_lshlrev_b32 v22, 16, v71
    v_and_b32 v23, 0xffff0000, v71
    v_fmac_f32 v20, v22, v103
    v_fmac_f32 v21, v23, v103
    v_lshlrev_b32 v22, 16, v72
    v_and_b32 v23, 0xffff0000, v72
    v_fmac_f32 v20, v22, v104
    v_fmac_f32 v21, v23, v104
    v_lshlrev_b32 v22, 16, v73
    v_and_b32 v23, 0xffff0000, v73
    v_fmac_f32 v20, v22, v105
    v_fmac_f32 v21, v23, v105
    v_lshlrev_b32 v22, 16, v74
    v_and_b32 v23, 0xffff0000, v74
    v_fmac_f32 v20, v22, v106
    v_fmac_f32 v21, v23, v106
    v_lshlrev_b32 v22, 16, v75
    v_and_b32 v23, 0xffff0000, v75
    v_fmac_f32 v20, v22, v107
    v_fmac_f32 v21, v23, v107
    v_lshlrev_b32 v22, 16, v76
    v_and_b32 v23, 0xffff0000, v76
    v_fmac_f32 v20, v22, v108
    v_fmac_f32 v21, v23, v108
    v_lshlrev_b32 v22, 16, v77
    v_and_b32 v23, 0xffff0000, v77
    v_fmac_f32 v20, v22, v109
    v_fmac_f32 v21, v23, v109
    v_lshlrev_b32 v22, 16, v78
    v_and_b32 v23, 0xffff0000, v78
    v_fmac_f32 v20, v22, v110
    v_fmac_f32 v21, v23, v110
    v_lshlrev_b32 v22, 16, v79
    v_and_b32 v23, 0xffff0000, v79
    v_fmac_f32 v20, v22, v111
    v_fmac_f32 v21, v23, v111
    v_lshlrev_b32 v22, 16, v80
    v_and_b32 v23, 0xffff0000, v80
    v_fmac_f32 v20, v22, v112
    v_fmac_f32 v21, v23, v112
    v_lshlrev_b32 v22, 16, v81
    v_and_b32 v23, 0xffff0000, v81
    v_fmac_f32 v20, v22, v113
    v_fmac_f32 v21, v23, v113
    v_lshlrev_b32 v22, 16, v82
    v_and_b32 v23, 0xffff0000, v82
    v_fmac_f32 v20, v22, v114
    v_fmac_f32 v21, v23, v114
    v_lshlrev_b32 v22, 16, v83
    v_and_b32 v23, 0xffff0000, v83
    v_fmac_f32 v20, v22, v115
    v_fmac_f32 v21, v23, v115
    v_lshlrev_b32 v22, 16, v84
    v_and_b32 v23, 0xffff0000, v84
    v_fmac_f32 v20, v22, v116
    v_fmac_f32 v21, v23, v116
    v_lshlrev_b32 v22, 16, v85
    v_and_b32 v23, 0xffff0000, v85
    v_fmac_f32 v20, v22, v117
    v_fmac_f32 v21, v23, v117
    v_lshlrev_b32 v22, 16, v86
    v_and_b32 v23, 0xffff0000, v86
    v_fmac_f32 v20, v22, v118
    v_fmac_f32 v21, v23, v118
    v_lshlrev_b32 v22, 16, v87
    v_and_b32 v23, 0xffff0000, v87
    v_fmac_f32 v20, v22, v119
    v_fmac_f32 v21, v23, v119
    v_lshlrev_b32 v22, 16, v88
    v_and_b32 v23, 0xffff0000, v88
    v_fmac_f32 v20, v22, v120
    v_fmac_f32 v21, v23, v120
    v_lshlrev_b32 v22, 16, v89
    v_and_b32 v23, 0xffff0000, v89
    v_fmac_f32 v20, v22, v121
    v_fmac_f32 v21, v23, v121
    v_lshlrev_b32 v22, 16, v90
    v_and_b32 v23, 0xffff0000, v90
    v_fmac_f32 v20, v22, v122
    v_fmac_f32 v21, v23, v122
    v_lshlrev_b32 v22, 16, v91
    v_and_b32 v23, 0xffff0000, v91
    v_fmac_f32 v20, v22, v123
    v_fmac_f32 v21, v23, v123
    v_lshlrev_b32 v22, 16, v92
    v_and_b32 v23, 0xffff0000, v92
    v_fmac_f32 v20, v22, v124
    v_fmac_f32 v21, v23, v124
    v_lshlrev_b32 v22, 16, v93
    v_and_b32 v23, 0xffff0000, v93
    v_fmac_f32 v20, v22, v125
    v_fmac_f32 v21, v23, v125
    v_lshlrev_b32 v22, 16, v94
    v_and_b32 v23, 0xffff0000, v94
    v_fmac_f32 v20, v22, v126
    v_fmac_f32 v21, v23, v126
    v_lshlrev_b32 v22, 16, v95
    v_and_b32 v23, 0xffff0000, v95
    v_fmac_f32 v20, v22, v127
    v_fmac_f32 v21, v23, v127
    v_xor_b32 v17, 32, v1
    v_lshlrev_b32 v17, 2, v17
    ds_bpermute_b32 v22, v17, v20
    ds_bpermute_b32 v23, v17, v21
    s_waitcnt lgkmcnt(0)
    v_add_f32 v20, v20, v22
    v_add_f32 v21, v21, v23
    v_cvt_pk_bf16_f32 v20, v20, v21
    v_and_b32 v11, 31, v1
    v_lshrrev_b32 v12, 4, v11
    v_lshlrev_b32 v12, 6, v12
    v_bfe_u32 v13, v11, 1, 2
    v_lshl_add_u32 v12, v13, 4, v12
    v_bfe_u32 v13, v11, 3, 1
    v_lshl_add_u32 v12, v13, 3, v12
    v_and_b32 v13, 1, v11
    v_lshl_add_u32 v12, v13, 2, v12
    s_lshl_b32 s44, s3, 7
    s_add_u32 s44, s44, 0x4400
    v_add_u32 v12, s44, v12
    ds_write_b32 v12, v20
    s_waitcnt vmcnt(0) lgkmcnt(0)
    s_barrier
    v_and_b32 v12, 3, v4
    v_lshlrev_b32 v12, 7, v12
    v_lshl_add_u32 v12, v3, 4, v12
    v_add_u32 v12, 0x4400, v12
    ds_read_b128 v[24:27], v12
    ds_read_b128 v[28:31], v12 offset:64
    v_lshrrev_b32 v14, 2, v4
    v_lshl_add_u32 v14, v3, 2, v14
    v_and_b32 v15, 7, v14
    v_lshlrev_b32 v15, 1, v15
    v_lshrrev_b32 v16, 3, v14
    v_or_b32 v15, v15, v16
    v_bfe_u32 v16, v4, 1, 1
    v_xor_b32 v15, v15, v16
    v_lshlrev_b32 v13, 8, v14
    v_lshl_add_u32 v13, v15, 4, v13
    v_and_b32 v16, 1, v4
    v_lshl_add_u32 v13, v16, 3, v13
    s_lshl_b32 s44, s3, 6
    v_xor_b32 v13, s44, v13
    v_lshlrev_b32 v14, 2, v1
    s_lshl_b32 s44, s41, 16
    s_lshl_b32 s45, s40, 9
    s_add_u32 s44, s44, s45
    s_lshl_b32 s45, s3, 7
    s_add_u32 s44, s44, s45
    s_add_u32 s44, s44, 12582912
    v_xor_b32 v16, 0, v13
    ds_read_b64_tr_b16 v[32:33], v16 offset:0
    ds_read_b64_tr_b16 v[34:35], v16 offset:4096
    ds_read_b64_tr_b16 v[36:37], v16 offset:8192
    ds_read_b64_tr_b16 v[38:39], v16 offset:12288
    s_waitcnt lgkmcnt(0)
    v_mfma_f32_16x16x32_bf16 v[40:43], v[24:27], v[32:35], 0
    v_mfma_f32_16x16x32_bf16 v[40:43], v[28:31], v[36:39], v[40:43]
    v_xor_b32 v16, 32, v13
    ds_read_b64_tr_b16 v[32:33], v16 offset:0
    ds_read_b64_tr_b16 v[34:35], v16 offset:4096
    ds_read_b64_tr_b16 v[36:37], v16 offset:8192
    ds_read_b64_tr_b16 v[38:39], v16 offset:12288
    s_waitcnt lgkmcnt(0)
    v_mfma_f32_16x16x32_bf16 v[44:47], v[24:27], v[32:35], 0
    v_mfma_f32_16x16x32_bf16 v[44:47], v[28:31], v[36:39], v[44:47]
    s_nop 7
    s_nop 3
    v_cmp_gt_u32 vcc, 16, v1
    s_and_saveexec_b64 s[60:61], vcc
    buffer_store_dword v40, v14, s[32:35], s44 offen offset:0
    buffer_store_dword v44, v14, s[32:35], s44 offen offset:64
    s_add_u32 s44, s44, 16384
    buffer_store_dword v41, v14, s[32:35], s44 offen offset:0
    buffer_store_dword v45, v14, s[32:35], s44 offen offset:64
    s_add_u32 s44, s44, 16384
    buffer_store_dword v42, v14, s[32:35], s44 offen offset:0
    buffer_store_dword v46, v14, s[32:35], s44 offen offset:64
    s_add_u32 s44, s44, 16384
    buffer_store_dword v43, v14, s[32:35], s44 offen offset:0
    buffer_store_dword v47, v14, s[32:35], s44 offen offset:64
    s_add_u32 s44, s44, 16384
K3_END:
    s_endpgm
.section .rodata,"a"
.p2align 6
.amdhsa_kernel k3_kernel
  .amdhsa_next_free_vgpr 128
  .amdhsa_next_free_sgpr 96
  .amdhsa_accum_offset 128
  .amdhsa_group_segment_fixed_size 0
  .amdhsa_kernarg_size 112
  .amdhsa_user_sgpr_count 2
  .amdhsa_user_sgpr_kernarg_segment_ptr 1
  .amdhsa_system_sgpr_workgroup_id_x 1
.end_amdhsa_kernel
.text
.globl k3b_kernel
.p2align 8
.type k3b_kernel,@function
k3b_kernel:
    s_cmp_ge_u32 s2, 184
    s_cbranch_scc1 K3B_END
    s_load_dwordx2 s[6:7], s[0:1], 40
    s_load_dwordx2 s[8:9], s[0:1], 72
    s_load_dwordx2 s[16:17], s[0:1], 104
    v_and_b32 v1, 63, v0
    v_lshrrev_b32 v2, 6, v0
    s_nop 0
    v_readfirstlane_b32 s3, v2
    v_lshrrev_b32 v3, 4, v1
    v_and_b32 v4, 15, v1
    s_waitcnt lgkmcnt(0)
    s_mov_b32 s32, s16
    s_and_b32 s33, s17, 0xffff
    s_mov_b32 s34, 13631488
    s_mov_b32 s35, 0x00020000
    s_sub_u32 s42, s2, 128
    s_mov_b32 s11, 4194304
    s_cmp_ge_u32 s2, 128
    s_cselect_b32 s6, s8, s6
    s_cselect_b32 s7, s9, s7
    s_cselect_b32 s10, 1835008, s11
    s_cselect_b32 s40, s42, s2
    s_mov_b32 s24, s6
    s_and_b32 s25, s7, 0xffff
    s_mov_b32 s26, s10
    s_mov_b32 s27, 0x00020000
    s_lshl_b32 s42, s40, 15
    s_lshl_b32 s43, s3, 13
    s_add_u32 s42, s42, s43
    s_and_b32 s44, s3, 1
    v_xor_b32 v7, s44, v1
    v_xor_b32 v8, 0, v7
    v_lshlrev_b32 v8, 4, v8
    s_add_u32 m0, s43, 0
    s_nop 0
    buffer_load_dwordx4 v8, s[24:27], s42 offen lds
    s_add_u32 s42, s42, 1024
    v_xor_b32 v8, 2, v7
    v_lshlrev_b32 v8, 4, v8
    s_add_u32 m0, s43, 1024
    s_nop 0
    buffer_load_dwordx4 v8, s[24:27], s42 offen lds
    s_add_u32 s42, s42, 1024
    v_xor_b32 v8, 4, v7
    v_lshlrev_b32 v8, 4, v8
    s_add_u32 m0, s43, 2048
    s_nop 0
    buffer_load_dwordx4 v8, s[24:27], s42 offen lds
    s_add_u32 s42, s42, 1024
    v_xor_b32 v8, 6, v7
    v_lshlrev_b32 v8, 4, v8
    s_add_u32 m0, s43, 3072
    s_nop 0
    buffer_load_dwordx4 v8, s[24:27], s42 offen lds
    s_add_u32 s42, s42, 1024
    v_xor_b32 v8, 8, v7
    v_lshlrev_b32 v8, 4, v8
    s_add_u32 m0, s43, 4096
    s_nop 0
    buffer_load_dwordx4 v8, s[24:27], s42 offen lds
    s_add_u32 s42, s42, 1024
    v_xor_b32 v8, 10, v7
    v_lshlrev_b32 v8, 4, v8
    s_add_u32 m0, s43, 5120
    s_nop 0
    buffer_load_dwordx4 v8, s[24:27], s42 offen lds
    s_add_u32 s42, s42, 1024
    v_xor_b32 v8, 12, v7
    v_lshlrev_b32 v8, 4, v8
    s_add_u32 m0, s43, 6144
    s_nop 0
    buffer_load_dwordx4 v8, s[24:27], s42 offen lds
    s_add_u32 s42, s42, 1024
    v_xor_b32 v8, 14, v7
    v_lshlrev_b32 v8, 4, v8
    s_add_u32 m0, s43, 7168
    s_nop 0
    buffer_load_dwordx4 v8, s[24:27], s42 offen lds
    s_add_u32 s42, s42, 1024
    v_bfe_u32 v9, v0, 5, 2
    v_and_b32 v10, 31, v0
    v_bfe_u32 v12, v10, 2, 2
    v_lshlrev_b32 v12, 4, v12
    v_bfe_u32 v13, v10, 4, 1
    v_lshl_add_u32 v12, v13, 3, v12
    v_and_b32 v13, 3, v10
    v_lshl_add_u32 v12, v13, 1, v12
    v_lshl_add_u32 v12, v9, 6, v12
    v_add_u32 v12, 0x8000, v12
    s_cmp_ge_u32 s2, 128
    s_cbranch_scc1 K3B_MLP
    v_lshlrev_b32 v11, 14, v9
    v_lshl_add_u32 v11, v10, 2, v11
    s_lshl_b32 s44, s2, 7
    s_add_u32 s44, s44, 12582912
    buffer_load_dword v20, v11, s[32:35], s44 offen
    s_add_u32 s44, s44, 65536
    buffer_load_dword v21, v11, s[32:35], s44 offen
    s_add_u32 s44, s44, 65536
    buffer_load_dword v22, v11, s[32:35], s44 offen
    s_add_u32 s44, s44, 65536
    buffer_load_dword v23, v11, s[32:35], s44 offen
    s_add_u32 s44, s44, 65536
    buffer_load_dword v24, v11, s[32:35], s44 offen
    s_add_u32 s44, s44, 65536
    buffer_load_dword v25, v11, s[32:35], s44 offen
    s_add_u32 s44, s44, 65536
    buffer_load_dword v26, v11, s[32:35], s44 offen
    s_add_u32 s44, s44, 65536
    buffer_load_dword v27, v11, s[32:35], s44 offen
    s_add_u32 s44, s44, 65536
    s_waitcnt vmcnt(0)
    v_add_f32 v20, v20, v21
    v_add_f32 v20, v20, v22
    v_add_f32 v20, v20, v23
    v_add_f32 v20, v20, v24
    v_add_f32 v20, v20, v25
    v_add_f32 v20, v20, v26
    v_add_f32 v20, v20, v27
    s_branch K3B_W
K3B_MLP:
    v_mul_u32_u24 v11, 7168, v9
    v_lshl_add_u32 v11, v10, 2, v11
    s_lshl_b32 s44, s40, 7
    s_add_u32 s44, s44, 524288
    s_add_u32 s45, s44, 28672
    buffer_load_dword v20, v11, s[32:35], s44 offen
    buffer_load_dword v21, v11, s[32:35], s45 offen
    s_waitcnt vmcnt(0)
    v_cvt_pk_bf16_f32 v20, v20, v20
    v_lshlrev_b32 v20, 16, v20
    v_cvt_pk_bf16_f32 v21, v21, v21
    v_lshlrev_b32 v21, 16, v21
    v_max_f32 v20, 0, v20
    v_mul_f32 v20, v20, v21
K3B_W:
    v_cvt_pk_bf16_f32 v20, v20, v20
    ds_write_b16 v12, v20
    s_waitcnt vmcnt(0) lgkmcnt(0)
    s_barrier
    v_and_b32 v12, 3, v4
    v_lshlrev_b32 v12, 6, v12
    v_lshl_add_u32 v12, v3, 4, v12
    v_add_u32 v12, 0x8000, v12
    ds_read_b128 v[24:27], v12
    v_lshrrev_b32 v14, 2, v4
    v_lshl_add_u32 v14, v3, 2, v14
    v_and_b32 v15, 7, v14
    v_lshlrev_b32 v15, 1, v15
    v_lshrrev_b32 v16, 3, v14
    v_or_b32 v15, v15, v16
    v_bfe_u32 v16, v4, 1, 1
    v_xor_b32 v15, v15, v16
    v_lshlrev_b32 v13, 10, v14
    v_lshl_add_u32 v13, v15, 4, v13
    v_and_b32 v16, 1, v4
    v_lshl_add_u32 v13, v16, 3, v13
    s_lshl_b32 s44, s3, 8
    v_add_u32 v13, s44, v13
    v_lshlrev_b32 v18, 2, v1
    s_lshl_b32 s45, s2, 13
    s_lshl_b32 s46, s3, 9
    s_add_u32 s45, s45, s46
    s_add_u32 s45, s45, 10616832
    v_cmp_gt_u32 vcc, 16, v1
    v_xor_b32 v16, 0, v13
    ds_read_b64_tr_b16 v[32:33], v16
    ds_read_b64_tr_b16 v[34:35], v16 offset:16384
    v_xor_b32 v16, 32, v13
    ds_read_b64_tr_b16 v[36:37], v16
    ds_read_b64_tr_b16 v[38:39], v16 offset:16384
    v_xor_b32 v16, 64, v13
    ds_read_b64_tr_b16 v[40:41], v16
    ds_read_b64_tr_b16 v[42:43], v16 offset:16384
    v_xor_b32 v16, 96, v13
    ds_read_b64_tr_b16 v[44:45], v16
    ds_read_b64_tr_b16 v[46:47], v16 offset:16384
    v_xor_b32 v16, 128, v13
    ds_read_b64_tr_b16 v[48:49], v16
    ds_read_b64_tr_b16 v[50:51], v16 offset:16384
    v_xor_b32 v16, 160, v13
    ds_read_b64_tr_b16 v[52:53], v16
    ds_read_b64_tr_b16 v[54:55], v16 offset:16384
    v_xor_b32 v16, 192, v13
    ds_read_b64_tr_b16 v[56:57], v16
    ds_read_b64_tr_b16 v[58:59], v16 offset:16384
    v_xor_b32 v16, 224, v13
    ds_read_b64_tr_b16 v[60:61], v16
    ds_read_b64_tr_b16 v[62:63], v16 offset:16384
    s_waitcnt lgkmcnt(0)
    v_mfma_f32_16x16x32_bf16 v[64:67], v[24:27], v[32:35], 0
    v_mfma_f32_16x16x32_bf16 v[68:71], v[24:27], v[36:39], 0
    v_mfma_f32_16x16x32_bf16 v[72:75], v[24:27], v[40:43], 0
    v_mfma_f32_16x16x32_bf16 v[76:79], v[24:27], v[44:47], 0
    v_mfma_f32_16x16x32_bf16 v[80:83], v[24:27], v[48:51], 0
    v_mfma_f32_16x16x32_bf16 v[84:87], v[24:27], v[52:55], 0
    v_mfma_f32_16x16x32_bf16 v[88:91], v[24:27], v[56:59], 0
    v_mfma_f32_16x16x32_bf16 v[92:95], v[24:27], v[60:63], 0
    s_nop 7
    s_nop 3
    s_and_saveexec_b64 s[60:61], vcc
    buffer_store_dword v64, v18, s[32:35], s45 offen offset:0
    buffer_store_dword v68, v18, s[32:35], s45 offen offset:64
    buffer_store_dword v72, v18, s[32:35], s45 offen offset:128
    buffer_store_dword v76, v18, s[32:35], s45 offen offset:192
    buffer_store_dword v80, v18, s[32:35], s45 offen offset:256
    buffer_store_dword v84, v18, s[32:35], s45 offen offset:320
    buffer_store_dword v88, v18, s[32:35], s45 offen offset:384
    buffer_store_dword v92, v18, s[32:35], s45 offen offset:448
    s_add_u32 s45, s45, 2048
    buffer_store_dword v65, v18, s[32:35], s45 offen offset:0
    buffer_store_dword v69, v18, s[32:35], s45 offen offset:64
    buffer_store_dword v73, v18, s[32:35], s45 offen offset:128
    buffer_store_dword v77, v18, s[32:35], s45 offen offset:192
    buffer_store_dword v81, v18, s[32:35], s45 offen offset:256
    buffer_store_dword v85, v18, s[32:35], s45 offen offset:320
    buffer_store_dword v89, v18, s[32:35], s45 offen offset:384
    buffer_store_dword v93, v18, s[32:35], s45 offen offset:448
    s_add_u32 s45, s45, 2048
    buffer_store_dword v66, v18, s[32:35], s45 offen offset:0
    buffer_store_dword v70, v18, s[32:35], s45 offen offset:64
    buffer_store_dword v74, v18, s[32:35], s45 offen offset:128
    buffer_store_dword v78, v18, s[32:35], s45 offen offset:192
    buffer_store_dword v82, v18, s[32:35], s45 offen offset:256
    buffer_store_dword v86, v18, s[32:35], s45 offen offset:320
    buffer_store_dword v90, v18, s[32:35], s45 offen offset:384
    buffer_store_dword v94, v18, s[32:35], s45 offen offset:448
    s_add_u32 s45, s45, 2048
    buffer_store_dword v67, v18, s[32:35], s45 offen offset:0
    buffer_store_dword v71, v18, s[32:35], s45 offen offset:64
    buffer_store_dword v75, v18, s[32:35], s45 offen offset:128
    buffer_store_dword v79, v18, s[32:35], s45 offen offset:192
    buffer_store_dword v83, v18, s[32:35], s45 offen offset:256
    buffer_store_dword v87, v18, s[32:35], s45 offen offset:320
    buffer_store_dword v91, v18, s[32:35], s45 offen offset:384
    buffer_store_dword v95, v18, s[32:35], s45 offen offset:448
    s_add_u32 s45, s45, 2048
K3B_END:
    s_endpgm
.section .rodata,"a"
.p2align 6
.amdhsa_kernel k3b_kernel
  .amdhsa_next_free_vgpr 96
  .amdhsa_next_free_sgpr 96
  .amdhsa_accum_offset 96
  .amdhsa_group_segment_fixed_size 0
  .amdhsa_kernarg_size 112
  .amdhsa_user_sgpr_count 2
  .amdhsa_user_sgpr_kernarg_segment_ptr 1
  .amdhsa_system_sgpr_workgroup_id_x 1
.end_amdhsa_kernel
.text
.globl k4_kernel
.p2align 8
.type k4_kernel,@function
k4_kernel:
    s_cmp_ge_u32 s2, 64
    s_cbranch_scc1 K4_END
    s_load_dwordx2 s[4:5], s[0:1], 0
    s_load_dwordx4 s[8:11], s[0:1], 80
    s_load_dwordx2 s[16:17], s[0:1], 104
    v_and_b32 v1, 63, v0
    v_lshrrev_b32 v2, 6, v0
    s_nop 0
    v_readfirstlane_b32 s3, v2
    v_lshrrev_b32 v3, 4, v1
    v_and_b32 v4, 15, v1
    s_waitcnt lgkmcnt(0)
    s_mov_b32 s20, s4
    s_and_b32 s21, s5, 0xffff
    s_mov_b32 s22, 4096
    s_mov_b32 s23, 0x00020000
    s_mov_b32 s24, s8
    s_and_b32 s25, s9, 0xffff
    s_mov_b32 s26, 1024
    s_mov_b32 s27, 0x00020000
    s_mov_b32 s28, s10
    s_and_b32 s29, s11, 0xffff
    s_mov_b32 s30, 4096
    s_mov_b32 s31, 0x00020000
    s_mov_b32 s32, s16
    s_and_b32 s33, s17, 0xffff
    s_mov_b32 s34, 13631488
    s_mov_b32 s35, 0x00020000
    s_lshr_b32 s40, s2, 4
    v_and_b32 v7, 31, v1
    v_lshrrev_b32 v8, 5, v0
    v_lshlrev_b32 v8, 13, v8
    v_lshl_add_u32 v8, v7, 2, v8
    s_lshl_b32 s42, s2, 7
    s_add_u32 s42, s42, 10616832
    buffer_load_dword v32, v8, s[32:35], s42 offen
    s_add_u32 s42, s42, 65536
    buffer_load_dword v33, v8, s[32:35], s42 offen
    s_add_u32 s42, s42, 65536
    buffer_load_dword v34, v8, s[32:35], s42 offen
    s_add_u32 s42, s42, 65536
    buffer_load_dword v35, v8, s[32:35], s42 offen
    s_add_u32 s42, s42, 65536
    buffer_load_dword v36, v8, s[32:35], s42 offen
    s_add_u32 s42, s42, 65536
    buffer_load_dword v37, v8, s[32:35], s42 offen
    s_add_u32 s42, s42, 65536
    buffer_load_dword v38, v8, s[32:35], s42 offen
    s_add_u32 s42, s42, 65536
    buffer_load_dword v39, v8, s[32:35], s42 offen
    s_add_u32 s42, s42, 65536
    buffer_load_dword v40, v8, s[32:35], s42 offen
    s_add_u32 s42, s42, 65536
    buffer_load_dword v41, v8, s[32:35], s42 offen
    s_add_u32 s42, s42, 65536
    buffer_load_dword v42, v8, s[32:35], s42 offen
    s_add_u32 s42, s42, 65536
    buffer_load_dword v43, v8, s[32:35], s42 offen
    s_add_u32 s42, s42, 65536
    buffer_load_dword v44, v8, s[32:35], s42 offen
    s_add_u32 s42, s42, 65536
    buffer_load_dword v45, v8, s[32:35], s42 offen
    s_add_u32 s42, s42, 65536
    buffer_load_dword v46, v8, s[32:35], s42 offen
    s_add_u32 s42, s42, 65536
    buffer_load_dword v47, v8, s[32:35], s42 offen
    s_add_u32 s42, s42, 65536
    buffer_load_dword v48, v8, s[32:35], s42 offen
    s_add_u32 s42, s42, 65536
    buffer_load_dword v49, v8, s[32:35], s42 offen
    s_add_u32 s42, s42, 65536
    buffer_load_dword v50, v8, s[32:35], s42 offen
    s_add_u32 s42, s42, 65536
    buffer_load_dword v51, v8, s[32:35], s42 offen
    s_add_u32 s42, s42, 65536
    buffer_load_dword v52, v8, s[32:35], s42 offen
    s_add_u32 s42, s42, 65536
    buffer_load_dword v53, v8, s[32:35], s42 offen
    s_add_u32 s42, s42, 65536
    buffer_load_dword v54, v8, s[32:35], s42 offen
    s_add_u32 s42, s42, 65536
    v_lshlrev_b32 v9, 4, v1
    s_lshl_b32 s43, s40, 10
    buffer_load_dwordx4 v[12:15], v9, s[20:23], s43 offen
    buffer_load_dwordx4 v[16:19], v9, s[24:27], 0 offen
    s_waitcnt vmcnt(2)
    v_add_f32 v32, v32, v33
    v_add_f32 v32, v32, v34
    v_add_f32 v32, v32, v35
    v_add_f32 v32, v32, v36
    v_add_f32 v32, v32, v37
    v_add_f32 v32, v32, v38
    v_add_f32 v32, v32, v39
    v_add_f32 v32, v32, v40
    v_add_f32 v32, v32, v41
    v_add_f32 v32, v32, v42
    v_add_f32 v32, v32, v43
    v_add_f32 v32, v32, v44
    v_add_f32 v32, v32, v45
    v_add_f32 v32, v32, v46
    v_add_f32 v32, v32, v47
    v_add_f32 v48, v48, v49
    v_add_f32 v48, v48, v50
    v_add_f32 v48, v48, v51
    v_add_f32 v48, v48, v52
    v_add_f32 v48, v48, v53
    v_add_f32 v48, v48, v54
    v_lshlrev_b32 v10, 2, v0
    ds_write_b32 v10, v32
    ds_write_b32 v10, v48 offset:1024
    s_waitcnt vmcnt(0) lgkmcnt(0)
    s_barrier
    s_cmp_lg_u32 s3, 0
    s_cbranch_scc1 K4_END
    v_mov_b32 v20, 0
    v_lshlrev_b32 v21, 16, v12
    v_lshlrev_b32 v22, 16, v16
    v_mul_f32 v21, v21, v22
    v_cvt_pk_bf16_f32 v21, v21, v21
    v_lshlrev_b32 v21, 16, v21
    v_add_f32 v20, v20, v21
    v_and_b32 v21, 0xffff0000, v12
    v_and_b32 v22, 0xffff0000, v16
    v_mul_f32 v21, v21, v22
    v_cvt_pk_bf16_f32 v21, v21, v21
    v_lshlrev_b32 v21, 16, v21
    v_add_f32 v20, v20, v21
    v_lshlrev_b32 v21, 16, v13
    v_lshlrev_b32 v22, 16, v17
    v_mul_f32 v21, v21, v22
    v_cvt_pk_bf16_f32 v21, v21, v21
    v_lshlrev_b32 v21, 16, v21
    v_add_f32 v20, v20, v21
    v_and_b32 v21, 0xffff0000, v13
    v_and_b32 v22, 0xffff0000, v17
    v_mul_f32 v21, v21, v22
    v_cvt_pk_bf16_f32 v21, v21, v21
    v_lshlrev_b32 v21, 16, v21
    v_add_f32 v20, v20, v21
    v_lshlrev_b32 v21, 16, v14
    v_lshlrev_b32 v22, 16, v18
    v_mul_f32 v21, v21, v22
    v_cvt_pk_bf16_f32 v21, v21, v21
    v_lshlrev_b32 v21, 16, v21
    v_add_f32 v20, v20, v21
    v_and_b32 v21, 0xffff0000, v14
    v_and_b32 v22, 0xffff0000, v18
    v_mul_f32 v21, v21, v22
    v_cvt_pk_bf16_f32 v21, v21, v21
    v_lshlrev_b32 v21, 16, v21
    v_add_f32 v20, v20, v21
    v_lshlrev_b32 v21, 16, v15
    v_lshlrev_b32 v22, 16, v19
    v_mul_f32 v21, v21, v22
    v_cvt_pk_bf16_f32 v21, v21, v21
    v_lshlrev_b32 v21, 16, v21
    v_add_f32 v20, v20, v21
    v_and_b32 v21, 0xffff0000, v15
    v_and_b32 v22, 0xffff0000, v19
    v_mul_f32 v21, v21, v22
    v_cvt_pk_bf16_f32 v21, v21, v21
    v_lshlrev_b32 v21, 16, v21
    v_add_f32 v20, v20, v21
    v_xor_b32 v22, 1, v1
    v_lshlrev_b32 v22, 2, v22
    ds_bpermute_b32 v21, v22, v20
    s_waitcnt lgkmcnt(0)
    v_add_f32 v20, v20, v21
    v_xor_b32 v22, 2, v1
    v_lshlrev_b32 v22, 2, v22
    ds_bpermute_b32 v21, v22, v20
    s_waitcnt lgkmcnt(0)
    v_add_f32 v20, v20, v21
    v_xor_b32 v22, 4, v1
    v_lshlrev_b32 v22, 2, v22
    ds_bpermute_b32 v21, v22, v20
    s_waitcnt lgkmcnt(0)
    v_add_f32 v20, v20, v21
    v_xor_b32 v22, 8, v1
    v_lshlrev_b32 v22, 2, v22
    ds_bpermute_b32 v21, v22, v20
    s_waitcnt lgkmcnt(0)
    v_add_f32 v20, v20, v21
    v_xor_b32 v22, 16, v1
    v_lshlrev_b32 v22, 2, v22
    ds_bpermute_b32 v21, v22, v20
    s_waitcnt lgkmcnt(0)
    v_add_f32 v20, v20, v21
    v_xor_b32 v22, 32, v1
    v_lshlrev_b32 v22, 2, v22
    ds_bpermute_b32 v21, v22, v20
    s_waitcnt lgkmcnt(0)
    v_add_f32 v20, v20, v21
    v_cvt_pk_bf16_f32 v20, v20, v20
    v_lshlrev_b32 v20, 16, v20
    v_mul_f32 v20, 0xbfb8aa3b, v20
    v_exp_f32 v20, v20
    s_nop 0
    v_add_f32 v20, 1.0, v20
    v_rcp_f32 v20, v20
    s_nop 0
    v_cvt_pk_bf16_f32 v20, v20, v20
    v_lshlrev_b32 v20, 16, v20
    v_sub_f32 v21, 1.0, v20
    v_cvt_pk_bf16_f32 v21, v21, v21
    v_lshlrev_b32 v21, 16, v21
    v_lshlrev_b32 v8, 2, v7
    ds_read_b32 v24, v8 offset:0
    ds_read_b32 v56, v8 offset:1024
    ds_read_b32 v25, v8 offset:128
    ds_read_b32 v57, v8 offset:1152
    ds_read_b32 v26, v8 offset:256
    ds_read_b32 v58, v8 offset:1280
    ds_read_b32 v27, v8 offset:384
    ds_read_b32 v59, v8 offset:1408
    ds_read_b32 v28, v8 offset:512
    ds_read_b32 v60, v8 offset:1536
    ds_read_b32 v29, v8 offset:640
    ds_read_b32 v61, v8 offset:1664
    ds_read_b32 v30, v8 offset:768
    ds_read_b32 v62, v8 offset:1792
    ds_read_b32 v31, v8 offset:896
    ds_read_b32 v63, v8 offset:1920
    s_waitcnt lgkmcnt(0)
    v_add_f32 v24, v24, v25
    v_add_f32 v56, v56, v57
    v_add_f32 v24, v24, v26
    v_add_f32 v56, v56, v58
    v_add_f32 v24, v24, v27
    v_add_f32 v56, v56, v59
    v_add_f32 v24, v24, v28
    v_add_f32 v56, v56, v60
    v_add_f32 v24, v24, v29
    v_add_f32 v56, v56, v61
    v_add_f32 v24, v24, v30
    v_add_f32 v56, v56, v62
    v_add_f32 v24, v24, v31
    v_add_f32 v56, v56, v63
    v_cvt_pk_bf16_f32 v24, v24, v24
    v_lshlrev_b32 v24, 16, v24
    v_cvt_pk_bf16_f32 v56, v56, v56
    v_lshlrev_b32 v56, 16, v56
    v_mul_f32 v24, v20, v24
    v_cvt_pk_bf16_f32 v24, v24, v24
    v_lshlrev_b32 v24, 16, v24
    v_mul_f32 v56, v21, v56
    v_cvt_pk_bf16_f32 v56, v56, v56
    v_lshlrev_b32 v56, 16, v56
    v_add_f32 v24, v24, v56
    v_cvt_pk_bf16_f32 v24, v24, v24
    v_lshlrev_b32 v9, 1, v7
    s_lshl_b32 s42, s2, 6
    v_cmp_gt_u32 vcc, 32, v1
    s_and_saveexec_b64 s[60:61], vcc
    buffer_store_short v24, v9, s[28:31], s42 offen
K4_END:
    s_endpgm
.section .rodata,"a"
.p2align 6
.amdhsa_kernel k4_kernel
  .amdhsa_next_free_vgpr 64
  .amdhsa_next_free_sgpr 96
  .amdhsa_accum_offset 64
  .amdhsa_group_segment_fixed_size 0
  .amdhsa_kernarg_size 112
  .amdhsa_user_sgpr_count 2
  .amdhsa_user_sgpr_kernarg_segment_ptr 1
  .amdhsa_system_sgpr_workgroup_id_x 1
.end_amdhsa_kernel
.text
```
